```python
import torch

def _softmax(x, axis=-1):
    return torch.softmax(x, dim=axis)
def _gelu(x):
    return torch.nn.functional.gelu(x, approximate="tanh")
def _silu(x):
    return torch.nn.functional.silu(x)
def _sigmoid(x):
    return torch.sigmoid(x)
def _layernorm(x, axis=-1, eps=1e-5):
    m = x.mean(dim=axis, keepdim=True)
    v = x.var(dim=axis, keepdim=True, unbiased=False)
    return (x - m) / torch.sqrt(v + eps)
def _scatter_add(tgt, idx, src, axis=0):
    return tgt.clone().index_add_(axis, idx, src)
def _segment_sum(src, seg, n):
    out = torch.zeros((n,) + src.shape[1:], dtype=src.dtype)
    return out.index_add_(0, seg, src)
def _pad(x, pw):
    flat = tuple(v for pair in reversed(pw) for v in pair)
    return torch.nn.functional.pad(x, flat)

kernel_name = 'standalone__glu_gated_swiglu__prompt'

def setup_inputs():

    _w = (lambda a: (lambda t: t.to(torch.bfloat16) if t.is_floating_point() else t)(torch.as_tensor(a)))
    B, S, D, F = 1, 2048, 640, 1536
    return {
        "x": _w((lambda *s: torch.randn(*s, dtype=torch.bfloat16) * 0.05)(B, S, D)),
        "w1": _w((lambda *s: torch.randn(*s, dtype=torch.bfloat16) * 0.05)(D, F) * (2.0 / D) ** 0.5),
        "w3": _w((lambda *s: torch.randn(*s, dtype=torch.bfloat16) * 0.05)(D, F) * (2.0 / D) ** 0.5),
        "w2": _w((lambda *s: torch.randn(*s, dtype=torch.bfloat16) * 0.05)(F, D) * (2.0 / F) ** 0.5),
    }

def reference(x, w1, w3, w2):
    gate = torch.einsum("bsd,df->bsf", x, w1)
    up = torch.einsum("bsd,df->bsf", x, w3)
    h = _silu(gate) * up
    out = torch.einsum("bsf,fd->bsd", h, w2)
    return out
```

```asm
; @launch grid=(256,1,1) block=(256,1,1) lds=163840
.amdgcn_target "amdgcn-amd-amdhsa--gfx950"
.text
.globl standalone__glu_gated_swiglu__prompt_kernel
.p2align 8
.type standalone__glu_gated_swiglu__prompt_kernel,@function
standalone__glu_gated_swiglu__prompt_kernel:
    s_cmp_ge_u32 s2, 256
    s_cbranch_scc1 L_end
    s_load_dwordx8 s[60:67], s[0:1], 0
    s_load_dwordx4 s[68:71], s[0:1], 32
    s_load_dwordx2 s[6:7], s[0:1], 48
    s_cmp_ge_u32 s2, 16
    s_cbranch_scc1 L_pfskip
    s_getpc_b64 s[50:51]
L_pfbase:
    v_min_u32 v52, (L_end - L_pfbase) / 128, v0
    v_lshlrev_b32 v52, 7, v52
    v_mov_b32 v54, s51
    v_add_co_u32 v52, vcc, s50, v52
    s_nop 1
    v_addc_co_u32 v53, vcc, 0, v54, vcc
    global_load_dword v63, v[52:53], off
L_pfskip:
    v_lshrrev_b32 v44, 6, v0
    v_and_b32 v1, 63, v0
    v_readfirstlane_b32 s32, v44
    s_and_b32 s49, s2, 1
    s_bfe_u32 s50, s2, 0x20001
    s_lshr_b32 s51, s2, 3
    v_lshrrev_b32 v47, 3, v1
    v_and_b32 v46, 7, v1
    s_and_b32 s53, s32, 1
    s_lshr_b32 s54, s32, 1
    s_cmp_ge_u32 s51, 30
    s_cbranch_scc1 L_pathB
    s_mul_i32 s52, s51, 52
    s_lshr_b32 s52, s52, 8
    s_mul_i32 s55, s52, 5
    s_sub_u32 s51, s51, s55
    s_mul_i32 s56, s50, 30
    s_add_u32 s55, s55, s56
    s_mul_i32 s55, s55, 43
    s_lshr_b32 s55, s55, 9
    s_lshl_b32 s34, s51, 1
    s_add_u32 s34, s34, s49
    s_add_u32 s34, s34, s55
    s_mul_i32 s56, s49, 5
    s_add_u32 s56, s56, s51
    s_mul_i32 s33, s50, 6
    s_add_u32 s33, s33, s52
    s_sub_u32 s55, s34, 10
    s_cmp_ge_u32 s34, 10
    s_cselect_b32 s34, s55, s34
    s_lshl_b32 s35, s34, 7
    s_mul_i32 s36, s34, 196608
    s_lshl_b32 s55, s54, 4
    v_add_u32 v44, s55, v47
    v_mul_u32_u24 v44, 3072, v44
    v_bfe_u32 v45, v1, 4, 1
    v_lshlrev_b32 v45, 1, v45
    v_xor_b32 v45, v45, v46
    s_lshl_b32 s55, s33, 7
    v_lshl_add_u32 v44, v45, 4, v44
    v_add_u32 v8, s55, v44
    v_xor_b32 v9, 64, v8
    v_add_u32 v9, 23552, v9
    s_mul_i32 s57, s56, 192
    v_lshrrev_b32 v44, 4, v1
    v_xor_b32 v44, v44, v46
    s_mul_i32 s55, s32, 48
    s_add_u32 s55, s55, s57
    v_add_u32 v45, s55, v47
    v_mul_u32_u24 v45, 1280, v45
    v_lshl_add_u32 v2, v44, 4, v45
    v_xor_b32 v44, 64, v2
    v_add_u32 v3, 9216, v44
    v_add_u32 v4, 18432, v2
    v_add_u32 v5, 30720, v44
    v_add_u32 v6, 39936, v2
    v_add_u32 v7, 49152, v44
    s_mul_i32 s37, s32, 6144
    s_lshl_b32 s38, s53, 12
    s_lshl_b32 s55, s54, 11
    s_add_u32 s38, s38, s55
    s_waitcnt lgkmcnt(0)
    s_bitcmp1_b32 s32, 0
    s_cselect_b32 s12, s64, s62
    s_cselect_b32 s13, s65, s63
    s_and_b32 s13, s13, 0xffff
    s_mov_b32 s14, 1966080
    s_mov_b32 s15, 0x20000
    s_mov_b32 s8, s60
    s_and_b32 s9, s61, 0xffff
    s_mov_b32 s10, 2621440
    s_mov_b32 s11, 0x20000
    s_or_b32 s49, s2, s32
    s_cbranch_scc1 L_notag
    s_memrealtime s[50:51]
    s_mov_b32 s28, s70
    s_and_b32 s29, s71, 0xffff
    s_mov_b32 s30, 256
    s_mov_b32 s31, 0x20000
    v_mov_b32 v50, 0
    s_waitcnt lgkmcnt(0)
    s_or_b32 s50, s50, 1
    v_mov_b32 v48, s50
    v_mov_b32 v49, s51
    s_mov_b64 exec, 1
    buffer_store_dwordx2 v[48:49], v50, s[28:31], 0 offen sc1
    s_mov_b64 exec, -1
L_notag:
    s_add_u32 m0, s38, 73728
    s_nop 0
    buffer_load_dwordx4 v8, s[12:15], s36 offen  lds
    buffer_load_dwordx4 v9, s[12:15], s36 offen offset:1024  lds
    s_add_u32 m0, s37, 0
    s_nop 0
    buffer_load_dwordx4 v2, s[8:11], s35 offen  lds
    buffer_load_dwordx4 v3, s[8:11], s35 offen offset:1024  lds
    buffer_load_dwordx4 v4, s[8:11], s35 offen offset:2048  lds
    s_add_u32 m0, s37, 3072
    s_nop 0
    buffer_load_dwordx4 v5, s[8:11], s35 offen  lds
    buffer_load_dwordx4 v6, s[8:11], s35 offen offset:1024  lds
    buffer_load_dwordx4 v7, s[8:11], s35 offen offset:2048  lds
    s_add_u32 s36, s36, 98304
    s_add_u32 m0, s38, 81920
    s_nop 0
    buffer_load_dwordx4 v8, s[12:15], s36 offen  lds
    buffer_load_dwordx4 v9, s[12:15], s36 offen offset:1024  lds
    s_mul_i32 s47, s2, 205
    s_lshr_b32 s47, s47, 10
    s_mul_i32 s52, s47, 5
    s_sub_u32 s48, s2, s52
    s_mul_i32 s3, s47, 40960
    s_lshl_b32 s52, s48, 8
    s_add_u32 s3, s3, s52
    s_mul_i32 s52, s32, 10240
    s_add_u32 s3, s3, s52
    s_add_u32 s4, s3, 5120
    v_lshrrev_b32 v44, 4, v1
    v_mul_u32_u24 v44, 1280, v44
    v_and_b32 v45, 15, v1
    v_lshl_add_u32 v18, v45, 4, v44
    s_mov_b32 s16, s66
    s_and_b32 s17, s67, 0xffff
    s_mov_b32 s18, 1966080
    s_mov_b32 s19, 0x20000
    s_mov_b32 s20, s6
    s_and_b32 s21, s7, 0xffff
    s_mov_b32 s22, 8323072
    s_mov_b32 s23, 0x20000
    s_and_b32 s49, s32, 1
    s_lshr_b32 s50, s32, 1
    v_and_b32 v44, 15, v1
    s_mul_i32 s51, s50, 96
    v_add_u32 v44, s51, v44
    v_lshlrev_b32 v44, 7, v44
    v_bfe_u32 v45, v1, 1, 3
    v_lshrrev_b32 v46, 4, v1
    v_xor_b32 v45, v45, v46
    v_lshl_add_u32 v10, v45, 4, v44
    v_xor_b32 v11, 64, v10
    v_bfe_u32 v47, v1, 2, 2
    v_lshl_add_u32 v44, v46, 3, v47
    v_lshlrev_b32 v44, 7, v44
    v_and_b32 v48, 3, v1
    v_lshl_add_u32 v44, v48, 3, v44
    v_bfe_u32 v48, v1, 3, 2
    s_lshl_b32 s51, s49, 1
    v_xor_b32 v48, s51, v48
    v_lshl_add_u32 v44, v48, 5, v44
    v_add_u32 v14, 73728, v44
    v_xor_b32 v15, 32, v14
    v_lshlrev_b32 v17, 4, v1
    v_lshlrev_b32 v156, 4, v1
    s_lshl_b32 s51, s33, 1
    s_add_u32 s51, s51, s49
    s_lshl_b32 s51, s51, 12
    s_lshl_b32 s52, s56, 1
    s_add_u32 s52, s52, s50
    s_mul_i32 s52, s52, 6
    s_add_u32 s53, s52, 0
    s_lshr_b32 s54, s53, 2
    s_mul_i32 s54, s54, 196608
    s_and_b32 s53, s53, 3
    s_lshl_b32 s53, s53, 10
    s_add_u32 s53, s53, s54
    s_add_u32 s41, s53, s51
    s_add_u32 s53, s52, 1
    s_lshr_b32 s54, s53, 2
    s_mul_i32 s54, s54, 196608
    s_and_b32 s53, s53, 3
    s_lshl_b32 s53, s53, 10
    s_add_u32 s53, s53, s54
    s_add_u32 s42, s53, s51
    s_add_u32 s53, s52, 2
    s_lshr_b32 s54, s53, 2
    s_mul_i32 s54, s54, 196608
    s_and_b32 s53, s53, 3
    s_lshl_b32 s53, s53, 10
    s_add_u32 s53, s53, s54
    s_add_u32 s43, s53, s51
    s_add_u32 s53, s52, 3
    s_lshr_b32 s54, s53, 2
    s_mul_i32 s54, s54, 196608
    s_and_b32 s53, s53, 3
    s_lshl_b32 s53, s53, 10
    s_add_u32 s53, s53, s54
    s_add_u32 s44, s53, s51
    s_add_u32 s53, s52, 4
    s_lshr_b32 s54, s53, 2
    s_mul_i32 s54, s54, 196608
    s_and_b32 s53, s53, 3
    s_lshl_b32 s53, s53, 10
    s_add_u32 s53, s53, s54
    s_add_u32 s45, s53, s51
    s_add_u32 s53, s52, 5
    s_lshr_b32 s54, s53, 2
    s_mul_i32 s54, s54, 196608
    s_and_b32 s53, s53, 3
    s_lshl_b32 s53, s53, 10
    s_add_u32 s53, s53, s54
    s_add_u32 s46, s53, s51
    s_mul_i32 s51, s56, 24
    s_add_u32 s51, s51, s33
    s_lshl_b32 s51, s51, 7
    s_add_u32 s7, s51, 6291456
    s_mov_b32 s24, s68
    s_and_b32 s25, s69, 0xffff
    s_mov_b32 s26, 2621440
    s_mov_b32 s27, 0x20000
    s_mov_b32 s28, s70
    s_and_b32 s29, s71, 0xffff
    s_mov_b32 s30, 256
    s_mov_b32 s31, 0x20000
    v_lshrrev_b32 v46, 4, v1
    v_and_b32 v50, 15, v1
    v_lshrrev_b32 v44, 2, v1
    v_lshlrev_b32 v44, 8, v44
    v_and_b32 v45, 3, v1
    v_lshl_add_u32 v44, v45, 3, v44
    s_lshl_b32 s51, s32, 6
    s_add_u32 s51, s51, 155648
    v_add_u32 v19, s51, v44
    s_mul_i32 s51, s48, 48
    s_add_u32 s51, s51, s47
    s_lshl_b32 s51, s51, 7
    s_add_u32 s6, s51, 6324224
    s_lshl_b32 s51, s48, 2
    s_add_u32 s51, s51, s32
    s_lshl_b32 s51, s51, 1
    s_mul_i32 s52, s47, 5120
    s_add_u32 s52, s52, 6356992
    s_add_u32 s53, s51, 0
    s_mul_i32 s54, s53, 52
    s_lshr_b32 s54, s54, 8
    s_mul_i32 s54, s54, 240640
    s_lshl_b32 s53, s53, 10
    s_add_u32 s53, s53, s54
    s_add_u32 s47, s53, s52
    s_add_u32 s53, s51, 1
    s_mul_i32 s54, s53, 52
    s_lshr_b32 s54, s54, 8
    s_mul_i32 s54, s54, 240640
    s_lshl_b32 s53, s53, 10
    s_add_u32 s53, s53, s54
    s_add_u32 s48, s53, s52
    s_cmp_eq_u32 s32, 0
    s_cselect_b32 s6, s6, 1073741824
    s_cselect_b32 s7, s7, 1073741824
    s_sub_u32 s51, s7, 128
    v_mov_b32 v44, s51
    v_mov_b32 v45, s6
    v_cmp_gt_u32 vcc, 8, v1
    v_lshlrev_b32 v47, 4, v1
    s_nop 0
    v_cndmask_b32 v44, v44, v45, vcc
    v_add_u32 v38, v44, v47
    s_mov_b32 s60, s35
    s_cmp_gt_u32 s35, 0
    s_cselect_b32 s61, 0, 128
    s_mov_b32 s57, 128
    s_mov_b32 s56, 256
    s_cmp_gt_u32 s35, 128
    s_cselect_b32 s62, s57, s56
    s_mov_b32 s57, 256
    s_mov_b32 s56, 384
    s_cmp_gt_u32 s35, 256
    s_cselect_b32 s63, s57, s56
    s_mov_b32 s57, 384
    s_mov_b32 s56, 512
    s_cmp_gt_u32 s35, 384
    s_cselect_b32 s64, s57, s56
    s_mov_b32 s57, 512
    s_mov_b32 s56, 640
    s_cmp_gt_u32 s35, 512
    s_cselect_b32 s65, s57, s56
    s_mov_b32 s57, 640
    s_mov_b32 s56, 768
    s_cmp_gt_u32 s35, 640
    s_cselect_b32 s66, s57, s56
    s_mov_b32 s57, 768
    s_mov_b32 s56, 896
    s_cmp_gt_u32 s35, 768
    s_cselect_b32 s67, s57, s56
    s_mov_b32 s57, 896
    s_mov_b32 s56, 1024
    s_cmp_gt_u32 s35, 896
    s_cselect_b32 s68, s57, s56
    s_mov_b32 s57, 1024
    s_mov_b32 s56, 1152
    s_cmp_gt_u32 s35, 1024
    s_cselect_b32 s69, s57, s56
    s_mov_b32 s57, 1152
    s_mov_b32 s56, 1280
    s_mov_b32 s58, 0xbfb8aa3b
    s_mov_b32 s59, 0xbfb8aa3b
    v_lshlrev_b32 v20, 4, v1
    v_lshrrev_b32 v46, 4, v1
    v_and_b32 v50, 15, v1
    s_and_b32 s49, s2, 7
    s_lshr_b32 s50, s2, 3
    s_lshr_b32 s56, s49, 1
    s_lshl_b32 s56, s56, 3
    s_lshr_b32 s51, s50, 2
    s_add_u32 s56, s56, s51
    s_and_b32 s57, s49, 1
    s_lshl_b32 s57, s57, 2
    s_and_b32 s52, s50, 3
    s_add_u32 s57, s57, s52
    s_mul_i32 s51, s51, 3
    s_lshr_b32 s51, s51, 1
    s_bfe_u32 s51, s50, 0x10002
    s_mul_i32 s51, s51, 6
    s_and_b32 s52, s57, 1
    s_mul_i32 s52, s52, 0
    s_add_u32 s52, s52, s51
    s_sub_u32 s51, s52, 12
    s_cmp_ge_u32 s52, 12
    s_cselect_b32 s52, s51, s52
    s_mul_i32 s53, s32, 12
    s_mul_i32 s54, s57, 48
    s_add_u32 s54, s54, s53
    s_mul_i32 s40, s54, 5120
    s_add_u32 s40, s40, 6356992
    s_mul_i32 s55, s52, 5120
    s_add_u32 s39, s40, s55
    s_add_u32 s40, s40, 61440
    s_mul_i32 s54, s56, 48
    s_add_u32 s54, s54, s53
    s_lshl_b32 s54, s54, 12
    s_mov_b32 s33, s54
    s_lshl_b32 s52, s52, 12
    s_add_u32 s70, s54, s52
    v_add_u32 v21, 4096, v20
    s_add_u32 s51, s32, 1
    s_and_b32 s51, s51, 3
    s_lshl_b32 s51, s51, 10
    v_add_u32 v22, s51, v20
    s_add_u32 s51, s32, 2
    s_and_b32 s51, s51, 3
    s_lshl_b32 s51, s51, 10
    v_add_u32 v23, s51, v20
    s_add_u32 s51, s32, 3
    s_and_b32 s51, s51, 3
    s_lshl_b32 s51, s51, 10
    v_add_u32 v24, s51, v20
    s_add_u32 s51, s32, 4
    s_and_b32 s51, s51, 3
    s_lshl_b32 s51, s51, 10
    v_add_u32 v25, s51, v20
    s_mul_i32 s51, s32, 5120
    v_add_u32 v26, s51, v20
    s_xor_b32 s51, s32, 2
    s_mul_i32 s51, s51, 5120
    v_add_u32 v27, s51, v20
    s_add_u32 s51, s32, 1
    s_and_b32 s51, s51, 3
    s_mul_i32 s51, s51, 5120
    v_add_u32 v28, s51, v20
    s_mul_i32 s55, s32, 2816
    s_add_u32 s55, s55, 61440
    v_mul_u32_u24 v44, 176, v50
    v_lshl_add_u32 v44, v46, 3, v44
    v_add_u32 v29, s55, v44
    s_lshl_b32 s53, s56, 2
    s_add_u32 s53, s53, s32
    s_mul_i32 s53, s53, 20480
    s_mul_i32 s54, s57, 160
    s_add_u32 s53, s53, s54
    v_add_u32 v44, 0, v1
    v_mul_u32_u24 v45, 205, v44
    v_lshrrev_b32 v45, 11, v45
    v_mul_u32_u24 v47, 10, v45
    v_sub_u32 v47, v44, v47
    v_lshlrev_b32 v47, 4, v47
    v_mul_u32_u24 v48, 176, v45
    v_add3_u32 v30, v48, v47, s55
    v_mul_u32_u24 v48, 1280, v45
    v_add3_u32 v33, v48, v47, s53
    v_add_u32 v44, 64, v1
    v_mul_u32_u24 v45, 205, v44
    v_lshrrev_b32 v45, 11, v45
    v_mul_u32_u24 v47, 10, v45
    v_sub_u32 v47, v44, v47
    v_lshlrev_b32 v47, 4, v47
    v_mul_u32_u24 v48, 176, v45
    v_add3_u32 v31, v48, v47, s55
    v_mul_u32_u24 v48, 1280, v45
    v_add3_u32 v34, v48, v47, s53
    v_add_u32 v44, 128, v1
    v_mul_u32_u24 v45, 205, v44
    v_lshrrev_b32 v45, 11, v45
    v_mul_u32_u24 v47, 10, v45
    v_sub_u32 v47, v44, v47
    v_lshlrev_b32 v47, 4, v47
    v_mul_u32_u24 v48, 176, v45
    v_add3_u32 v32, v48, v47, s55
    v_mul_u32_u24 v48, 1280, v45
    v_add3_u32 v35, v48, v47, s53
    v_lshrrev_b32 v44, 5, v1
    v_lshlrev_b32 v44, 30, v44
    v_add_u32 v35, v35, v44
    s_mul_i32 s51, s56, 86
    s_lshr_b32 s51, s51, 8
    s_mul_i32 s51, s51, 24
    s_cmp_ge_u32 s56, 30
    s_cselect_b32 s52, 4, 6
    s_mul_i32 s53, s52, s32
    s_add_u32 s51, s51, s53
    s_sub_u32 s52, s52, 1
    s_lshl_b32 s51, s51, 7
    s_add_u32 s51, s51, 6291456
    v_min_u32 v44, s52, v1
    v_lshlrev_b32 v44, 7, v44
    v_add_u32 v36, s51, v44
    s_mul_i32 s51, s57, 5
    s_add_u32 s52, s51, 4
    s_lshr_b32 s51, s51, 3
    s_lshr_b32 s52, s52, 3
    s_sub_u32 s52, s52, s51
    s_mul_i32 s52, s52, 6144
    s_lshl_b32 s51, s51, 2
    s_add_u32 s51, s51, s32
    s_mul_i32 s51, s51, 1536
    s_add_u32 s51, s51, 6324224
    v_and_b32 v44, 31, v1
    v_min_u32 v44, 11, v44
    v_lshlrev_b32 v44, 7, v44
    v_lshrrev_b32 v45, 5, v1
    v_mul_u32_u24 v45, s52, v45
    v_add3_u32 v37, v44, v45, s51
    s_lshl_b32 m0, s32, 11
    s_add_u32 m0, m0, 155648
    s_nop 0
    buffer_load_dwordx4 v18, s[16:19], s3 offen nt lds
    s_lshl_b32 m0, s32, 11
    s_add_u32 m0, m0, 156672
    s_nop 0
    buffer_load_dwordx4 v18, s[16:19], s4 offen nt lds
    s_add_u32 m0, s37, 24576
    s_nop 0
    buffer_load_dwordx4 v2, s[8:11], s61 offen  lds
    buffer_load_dwordx4 v3, s[8:11], s61 offen offset:1024  lds
    s_waitcnt vmcnt(6)
    s_barrier
    ds_read_b128 v[80:83], v10 offset:0
    ds_read_b64_tr_b16 v[64:65], v14 offset:0
    ds_read_b64_tr_b16 v[66:67], v14 offset:512
    ds_read_b64_tr_b16 v[68:69], v15 offset:0
    ds_read_b64_tr_b16 v[70:71], v15 offset:512
    ds_read_b64_tr_b16 v[72:73], v14 offset:4096
    ds_read_b64_tr_b16 v[74:75], v14 offset:4608
    ds_read_b64_tr_b16 v[76:77], v15 offset:4096
    ds_read_b64_tr_b16 v[78:79], v15 offset:4608
    ds_read_b128 v[84:87], v10 offset:2048
    ds_read_b128 v[88:91], v10 offset:4096
    ds_read_b128 v[92:95], v10 offset:6144
    ds_read_b128 v[96:99], v10 offset:8192
    ds_read_b128 v[100:103], v10 offset:10240
    s_waitcnt lgkmcnt(11)
    v_mfma_f32_16x16x32_bf16 v[160:163], v[64:67], v[80:83], 0
    s_waitcnt lgkmcnt(9)
    v_mfma_f32_16x16x32_bf16 v[164:167], v[68:71], v[80:83], 0
    buffer_load_dwordx4 v4, s[8:11], s61 offen offset:2048  lds
    s_waitcnt lgkmcnt(7)
    v_mfma_f32_16x16x32_bf16 v[168:171], v[72:75], v[80:83], 0
    s_waitcnt lgkmcnt(5)
    v_mfma_f32_16x16x32_bf16 v[172:175], v[76:79], v[80:83], 0
    s_add_u32 m0, s37, 27648
    s_waitcnt lgkmcnt(4)
    v_mfma_f32_16x16x32_bf16 v[176:179], v[64:67], v[84:87], 0
    buffer_load_dwordx4 v5, s[8:11], s61 offen  lds
    v_mfma_f32_16x16x32_bf16 v[180:183], v[68:71], v[84:87], 0
    v_mfma_f32_16x16x32_bf16 v[184:187], v[72:75], v[84:87], 0
    v_mfma_f32_16x16x32_bf16 v[188:191], v[76:79], v[84:87], 0
    buffer_load_dwordx4 v6, s[8:11], s61 offen offset:1024  lds
    s_waitcnt lgkmcnt(3)
    v_mfma_f32_16x16x32_bf16 v[192:195], v[64:67], v[88:91], 0
    s_waitcnt lgkmcnt(0)
    v_mfma_f32_16x16x32_bf16 v[196:199], v[68:71], v[88:91], 0
    s_waitcnt vmcnt(7)
    s_barrier
    v_mfma_f32_16x16x32_bf16 v[200:203], v[72:75], v[88:91], 0
    buffer_load_dwordx4 v7, s[8:11], s61 offen offset:2048  lds
    ds_read_b128 v[120:123], v11 offset:0
    v_mfma_f32_16x16x32_bf16 v[204:207], v[76:79], v[88:91], 0
    ds_read_b64_tr_b16 v[104:105], v14 offset:8192
    v_mfma_f32_16x16x32_bf16 v[208:211], v[64:67], v[92:95], 0
    ds_read_b64_tr_b16 v[106:107], v14 offset:8704
    s_mul_i32 s36, s61, 1536
    s_add_u32 m0, s38, 90112
    v_mfma_f32_16x16x32_bf16 v[212:215], v[68:71], v[92:95], 0
    buffer_load_dwordx4 v8, s[12:15], s36 offen  lds
    ds_read_b64_tr_b16 v[108:109], v15 offset:8192
    v_mfma_f32_16x16x32_bf16 v[216:219], v[72:75], v[92:95], 0
    ds_read_b64_tr_b16 v[110:111], v15 offset:8704
    v_mfma_f32_16x16x32_bf16 v[220:223], v[76:79], v[92:95], 0
    ds_read_b64_tr_b16 v[112:113], v14 offset:12288
    v_mfma_f32_16x16x32_bf16 v[224:227], v[64:67], v[96:99], 0
    buffer_load_dwordx4 v9, s[12:15], s36 offen offset:1024  lds
    ds_read_b64_tr_b16 v[114:115], v14 offset:12800
    v_mfma_f32_16x16x32_bf16 v[228:231], v[68:71], v[96:99], 0
    ds_read_b64_tr_b16 v[116:117], v15 offset:12288
    v_mfma_f32_16x16x32_bf16 v[232:235], v[72:75], v[96:99], 0
    ds_read_b64_tr_b16 v[118:119], v15 offset:12800
    s_add_u32 m0, s37, 49152
    v_mfma_f32_16x16x32_bf16 v[236:239], v[76:79], v[96:99], 0
    buffer_load_dwordx4 v2, s[8:11], s62 offen  lds
    ds_read_b128 v[124:127], v11 offset:2048
    v_mfma_f32_16x16x32_bf16 v[240:243], v[64:67], v[100:103], 0
    ds_read_b128 v[128:131], v11 offset:4096
    v_mfma_f32_16x16x32_bf16 v[244:247], v[68:71], v[100:103], 0
    ds_read_b128 v[132:135], v11 offset:6144
    v_mfma_f32_16x16x32_bf16 v[248:251], v[72:75], v[100:103], 0
    buffer_load_dwordx4 v3, s[8:11], s62 offen offset:1024  lds
    ds_read_b128 v[136:139], v11 offset:8192
    v_mfma_f32_16x16x32_bf16 v[252:255], v[76:79], v[100:103], 0
    ds_read_b128 v[140:143], v11 offset:10240
    s_waitcnt lgkmcnt(11)
    v_mfma_f32_16x16x32_bf16 v[160:163], v[104:107], v[120:123], v[160:163]
    s_waitcnt lgkmcnt(9)
    v_mfma_f32_16x16x32_bf16 v[164:167], v[108:111], v[120:123], v[164:167]
    buffer_load_dwordx4 v4, s[8:11], s62 offen offset:2048  lds
    s_add_u32 s36, s36, 98304
    s_add_u32 m0, s38, 98304
    s_waitcnt lgkmcnt(7)
    v_mfma_f32_16x16x32_bf16 v[168:171], v[112:115], v[120:123], v[168:171]
    buffer_load_dwordx4 v8, s[12:15], s36 offen  lds
    s_waitcnt lgkmcnt(5)
    v_mfma_f32_16x16x32_bf16 v[172:175], v[116:119], v[120:123], v[172:175]
    s_waitcnt lgkmcnt(4)
    v_mfma_f32_16x16x32_bf16 v[176:179], v[104:107], v[124:127], v[176:179]
    buffer_load_dwordx4 v9, s[12:15], s36 offen offset:1024  lds
    s_add_u32 m0, s37, 52224
    v_mfma_f32_16x16x32_bf16 v[180:183], v[108:111], v[124:127], v[180:183]
    buffer_load_dwordx4 v5, s[8:11], s62 offen  lds
    v_mfma_f32_16x16x32_bf16 v[184:187], v[112:115], v[124:127], v[184:187]
    v_mfma_f32_16x16x32_bf16 v[188:191], v[116:119], v[124:127], v[188:191]
    buffer_load_dwordx4 v6, s[8:11], s62 offen offset:1024  lds
    s_waitcnt lgkmcnt(3)
    v_mfma_f32_16x16x32_bf16 v[192:195], v[104:107], v[128:131], v[192:195]
    s_waitcnt lgkmcnt(0)
    v_mfma_f32_16x16x32_bf16 v[196:199], v[108:111], v[128:131], v[196:199]
    s_waitcnt vmcnt(7)
    s_barrier
    v_mfma_f32_16x16x32_bf16 v[200:203], v[112:115], v[128:131], v[200:203]
    buffer_load_dwordx4 v7, s[8:11], s62 offen offset:2048  lds
    ds_read_b128 v[80:83], v10 offset:24576
    v_mfma_f32_16x16x32_bf16 v[204:207], v[116:119], v[128:131], v[204:207]
    ds_read_b64_tr_b16 v[64:65], v14 offset:16384
    v_mfma_f32_16x16x32_bf16 v[208:211], v[104:107], v[132:135], v[208:211]
    ds_read_b64_tr_b16 v[66:67], v14 offset:16896
    s_mul_i32 s36, s62, 1536
    s_add_u32 m0, s38, 106496
    v_mfma_f32_16x16x32_bf16 v[212:215], v[108:111], v[132:135], v[212:215]
    buffer_load_dwordx4 v8, s[12:15], s36 offen  lds
    ds_read_b64_tr_b16 v[68:69], v15 offset:16384
    v_mfma_f32_16x16x32_bf16 v[216:219], v[112:115], v[132:135], v[216:219]
    ds_read_b64_tr_b16 v[70:71], v15 offset:16896
    v_mfma_f32_16x16x32_bf16 v[220:223], v[116:119], v[132:135], v[220:223]
    ds_read_b64_tr_b16 v[72:73], v14 offset:20480
    v_mfma_f32_16x16x32_bf16 v[224:227], v[104:107], v[136:139], v[224:227]
    buffer_load_dwordx4 v9, s[12:15], s36 offen offset:1024  lds
    ds_read_b64_tr_b16 v[74:75], v14 offset:20992
    v_mfma_f32_16x16x32_bf16 v[228:231], v[108:111], v[136:139], v[228:231]
    ds_read_b64_tr_b16 v[76:77], v15 offset:20480
    v_mfma_f32_16x16x32_bf16 v[232:235], v[112:115], v[136:139], v[232:235]
    ds_read_b64_tr_b16 v[78:79], v15 offset:20992
    s_add_u32 m0, s37, 0
    v_mfma_f32_16x16x32_bf16 v[236:239], v[116:119], v[136:139], v[236:239]
    buffer_load_dwordx4 v2, s[8:11], s63 offen  lds
    ds_read_b128 v[84:87], v10 offset:26624
    v_mfma_f32_16x16x32_bf16 v[240:243], v[104:107], v[140:143], v[240:243]
    ds_read_b128 v[88:91], v10 offset:28672
    v_mfma_f32_16x16x32_bf16 v[244:247], v[108:111], v[140:143], v[244:247]
    ds_read_b128 v[92:95], v10 offset:30720
    v_mfma_f32_16x16x32_bf16 v[248:251], v[112:115], v[140:143], v[248:251]
    buffer_load_dwordx4 v3, s[8:11], s63 offen offset:1024  lds
    ds_read_b128 v[96:99], v10 offset:32768
    v_mfma_f32_16x16x32_bf16 v[252:255], v[116:119], v[140:143], v[252:255]
    ds_read_b128 v[100:103], v10 offset:34816
    s_waitcnt lgkmcnt(11)
    v_mfma_f32_16x16x32_bf16 v[160:163], v[64:67], v[80:83], v[160:163]
    s_waitcnt lgkmcnt(9)
    v_mfma_f32_16x16x32_bf16 v[164:167], v[68:71], v[80:83], v[164:167]
    buffer_load_dwordx4 v4, s[8:11], s63 offen offset:2048  lds
    s_waitcnt lgkmcnt(7)
    v_mfma_f32_16x16x32_bf16 v[168:171], v[72:75], v[80:83], v[168:171]
    s_waitcnt lgkmcnt(5)
    v_mfma_f32_16x16x32_bf16 v[172:175], v[76:79], v[80:83], v[172:175]
    s_add_u32 s36, s36, 98304
    s_add_u32 m0, s38, 114688
    s_waitcnt lgkmcnt(4)
    v_mfma_f32_16x16x32_bf16 v[176:179], v[64:67], v[84:87], v[176:179]
    buffer_load_dwordx4 v8, s[12:15], s36 offen  lds
    v_mfma_f32_16x16x32_bf16 v[180:183], v[68:71], v[84:87], v[180:183]
    v_mfma_f32_16x16x32_bf16 v[184:187], v[72:75], v[84:87], v[184:187]
    v_mfma_f32_16x16x32_bf16 v[188:191], v[76:79], v[84:87], v[188:191]
    buffer_load_dwordx4 v9, s[12:15], s36 offen offset:1024  lds
    s_waitcnt lgkmcnt(3)
    v_mfma_f32_16x16x32_bf16 v[192:195], v[64:67], v[88:91], v[192:195]
    s_waitcnt lgkmcnt(0)
    v_mfma_f32_16x16x32_bf16 v[196:199], v[68:71], v[88:91], v[196:199]
    s_waitcnt vmcnt(10)
    s_barrier
    v_mfma_f32_16x16x32_bf16 v[200:203], v[72:75], v[88:91], v[200:203]
    ds_read_b128 v[120:123], v11 offset:24576
    v_mfma_f32_16x16x32_bf16 v[204:207], v[76:79], v[88:91], v[204:207]
    ds_read_b64_tr_b16 v[104:105], v14 offset:24576
    v_mfma_f32_16x16x32_bf16 v[208:211], v[64:67], v[92:95], v[208:211]
    ds_read_b64_tr_b16 v[106:107], v14 offset:25088
    s_add_u32 m0, s37, 3072
    v_mfma_f32_16x16x32_bf16 v[212:215], v[68:71], v[92:95], v[212:215]
    buffer_load_dwordx4 v5, s[8:11], s63 offen  lds
    ds_read_b64_tr_b16 v[108:109], v15 offset:24576
    v_mfma_f32_16x16x32_bf16 v[216:219], v[72:75], v[92:95], v[216:219]
    ds_read_b64_tr_b16 v[110:111], v15 offset:25088
    v_mfma_f32_16x16x32_bf16 v[220:223], v[76:79], v[92:95], v[220:223]
    ds_read_b64_tr_b16 v[112:113], v14 offset:28672
    v_mfma_f32_16x16x32_bf16 v[224:227], v[64:67], v[96:99], v[224:227]
    buffer_load_dwordx4 v6, s[8:11], s63 offen offset:1024  lds
    ds_read_b64_tr_b16 v[114:115], v14 offset:29184
    v_mfma_f32_16x16x32_bf16 v[228:231], v[68:71], v[96:99], v[228:231]
    ds_read_b64_tr_b16 v[116:117], v15 offset:28672
    v_mfma_f32_16x16x32_bf16 v[232:235], v[72:75], v[96:99], v[232:235]
    ds_read_b64_tr_b16 v[118:119], v15 offset:29184
    v_mfma_f32_16x16x32_bf16 v[236:239], v[76:79], v[96:99], v[236:239]
    buffer_load_dwordx4 v7, s[8:11], s63 offen offset:2048  lds
    ds_read_b128 v[124:127], v11 offset:26624
    v_mfma_f32_16x16x32_bf16 v[240:243], v[64:67], v[100:103], v[240:243]
    ds_read_b128 v[128:131], v11 offset:28672
    v_mfma_f32_16x16x32_bf16 v[244:247], v[68:71], v[100:103], v[244:247]
    ds_read_b128 v[132:135], v11 offset:30720
    v_mfma_f32_16x16x32_bf16 v[248:251], v[72:75], v[100:103], v[248:251]
    ds_read_b128 v[136:139], v11 offset:32768
    v_mfma_f32_16x16x32_bf16 v[252:255], v[76:79], v[100:103], v[252:255]
    ds_read_b128 v[140:143], v11 offset:34816
    s_waitcnt lgkmcnt(11)
    v_mfma_f32_16x16x32_bf16 v[160:163], v[104:107], v[120:123], v[160:163]
    s_mul_i32 s36, s63, 1536
    s_add_u32 m0, s38, 73728
    s_waitcnt lgkmcnt(9)
    v_mfma_f32_16x16x32_bf16 v[164:167], v[108:111], v[120:123], v[164:167]
    buffer_load_dwordx4 v8, s[12:15], s36 offen  lds
    ds_read_b64_tr_b16 v[144:145], v19 offset:0
    ds_read_b64_tr_b16 v[146:147], v19 offset:4096
    s_waitcnt lgkmcnt(9)
    v_mfma_f32_16x16x32_bf16 v[168:171], v[112:115], v[120:123], v[168:171]
    s_waitcnt lgkmcnt(7)
    v_mfma_f32_16x16x32_bf16 v[172:175], v[116:119], v[120:123], v[172:175]
    ds_read_b64_tr_b16 v[148:149], v19 offset:32
    ds_read_b64_tr_b16 v[150:151], v19 offset:4128
    s_waitcnt lgkmcnt(8)
    v_mfma_f32_16x16x32_bf16 v[176:179], v[104:107], v[124:127], v[176:179]
    buffer_load_dwordx4 v9, s[12:15], s36 offen offset:1024  lds
    v_mfma_f32_16x16x32_bf16 v[180:183], v[108:111], v[124:127], v[180:183]
    v_mfma_f32_16x16x32_bf16 v[184:187], v[112:115], v[124:127], v[184:187]
    v_mfma_f32_16x16x32_bf16 v[188:191], v[116:119], v[124:127], v[188:191]
    s_waitcnt lgkmcnt(7)
    v_mfma_f32_16x16x32_bf16 v[192:195], v[104:107], v[128:131], v[192:195]
    s_waitcnt lgkmcnt(0)
    v_mfma_f32_16x16x32_bf16 v[196:199], v[108:111], v[128:131], v[196:199]
    s_waitcnt vmcnt(10)
    s_barrier
    v_mfma_f32_16x16x32_bf16 v[200:203], v[112:115], v[128:131], v[200:203]
    ds_read_b128 v[80:83], v10 offset:49152
    v_mfma_f32_16x16x32_bf16 v[204:207], v[116:119], v[128:131], v[204:207]
    ds_read_b64_tr_b16 v[64:65], v14 offset:32768
    v_mfma_f32_16x16x32_bf16 v[208:211], v[104:107], v[132:135], v[208:211]
    ds_read_b64_tr_b16 v[66:67], v14 offset:33280
    s_add_u32 m0, s37, 24576
    v_mfma_f32_16x16x32_bf16 v[212:215], v[108:111], v[132:135], v[212:215]
    buffer_load_dwordx4 v2, s[8:11], s64 offen  lds
    ds_read_b64_tr_b16 v[68:69], v15 offset:32768
    v_mfma_f32_16x16x32_bf16 v[216:219], v[112:115], v[132:135], v[216:219]
    ds_read_b64_tr_b16 v[70:71], v15 offset:33280
    v_mfma_f32_16x16x32_bf16 v[220:223], v[116:119], v[132:135], v[220:223]
    ds_read_b64_tr_b16 v[72:73], v14 offset:36864
    v_mfma_f32_16x16x32_bf16 v[224:227], v[104:107], v[136:139], v[224:227]
    buffer_load_dwordx4 v3, s[8:11], s64 offen offset:1024  lds
    ds_read_b64_tr_b16 v[74:75], v14 offset:37376
    v_mfma_f32_16x16x32_bf16 v[228:231], v[108:111], v[136:139], v[228:231]
    ds_read_b64_tr_b16 v[76:77], v15 offset:36864
    v_mfma_f32_16x16x32_bf16 v[232:235], v[112:115], v[136:139], v[232:235]
    ds_read_b64_tr_b16 v[78:79], v15 offset:37376
    v_mfma_f32_16x16x32_bf16 v[236:239], v[116:119], v[136:139], v[236:239]
    buffer_load_dwordx4 v4, s[8:11], s64 offen offset:2048  lds
    ds_read_b128 v[84:87], v10 offset:51200
    v_mfma_f32_16x16x32_bf16 v[240:243], v[104:107], v[140:143], v[240:243]
    ds_read_b128 v[88:91], v10 offset:53248
    v_mfma_f32_16x16x32_bf16 v[244:247], v[108:111], v[140:143], v[244:247]
    ds_read_b128 v[92:95], v10 offset:55296
    s_add_u32 s36, s36, 98304
    s_add_u32 m0, s38, 81920
    v_mfma_f32_16x16x32_bf16 v[248:251], v[112:115], v[140:143], v[248:251]
    buffer_load_dwordx4 v8, s[12:15], s36 offen  lds
    ds_read_b128 v[96:99], v10 offset:57344
    v_mfma_f32_16x16x32_bf16 v[252:255], v[116:119], v[140:143], v[252:255]
    ds_read_b128 v[100:103], v10 offset:59392
    s_waitcnt lgkmcnt(11)
    v_mfma_f32_16x16x32_bf16 v[160:163], v[64:67], v[80:83], v[160:163]
    s_waitcnt lgkmcnt(9)
    v_mfma_f32_16x16x32_bf16 v[164:167], v[68:71], v[80:83], v[164:167]
    buffer_load_dwordx4 v9, s[12:15], s36 offen offset:1024  lds
    buffer_store_dwordx4 v[144:147], v20, s[20:23], s47 offen sc1
    s_waitcnt lgkmcnt(7)
    v_mfma_f32_16x16x32_bf16 v[168:171], v[72:75], v[80:83], v[168:171]
    s_waitcnt lgkmcnt(5)
    v_mfma_f32_16x16x32_bf16 v[172:175], v[76:79], v[80:83], v[172:175]
    buffer_store_dwordx4 v[148:151], v20, s[20:23], s48 offen sc1
    s_add_u32 m0, s37, 27648
    s_waitcnt lgkmcnt(4)
    v_mfma_f32_16x16x32_bf16 v[176:179], v[64:67], v[84:87], v[176:179]
    buffer_load_dwordx4 v5, s[8:11], s64 offen  lds
    v_mfma_f32_16x16x32_bf16 v[180:183], v[68:71], v[84:87], v[180:183]
    v_mfma_f32_16x16x32_bf16 v[184:187], v[72:75], v[84:87], v[184:187]
    v_mfma_f32_16x16x32_bf16 v[188:191], v[76:79], v[84:87], v[188:191]
    buffer_load_dwordx4 v6, s[8:11], s64 offen offset:1024  lds
    s_waitcnt lgkmcnt(3)
    v_mfma_f32_16x16x32_bf16 v[192:195], v[64:67], v[88:91], v[192:195]
    s_waitcnt lgkmcnt(0)
    v_mfma_f32_16x16x32_bf16 v[196:199], v[68:71], v[88:91], v[196:199]
    s_waitcnt vmcnt(14)
    s_barrier
    v_mfma_f32_16x16x32_bf16 v[200:203], v[72:75], v[88:91], v[200:203]
    ds_read_b128 v[120:123], v11 offset:49152
    v_mfma_f32_16x16x32_bf16 v[204:207], v[76:79], v[88:91], v[204:207]
    ds_read_b64_tr_b16 v[104:105], v14 offset:40960
    v_mfma_f32_16x16x32_bf16 v[208:211], v[64:67], v[92:95], v[208:211]
    ds_read_b64_tr_b16 v[106:107], v14 offset:41472
    v_mfma_f32_16x16x32_bf16 v[212:215], v[68:71], v[92:95], v[212:215]
    buffer_load_dwordx4 v7, s[8:11], s64 offen offset:2048  lds
    ds_read_b64_tr_b16 v[108:109], v15 offset:40960
    v_mfma_f32_16x16x32_bf16 v[216:219], v[72:75], v[92:95], v[216:219]
    ds_read_b64_tr_b16 v[110:111], v15 offset:41472
    v_mfma_f32_16x16x32_bf16 v[220:223], v[76:79], v[92:95], v[220:223]
    ds_read_b64_tr_b16 v[112:113], v14 offset:45056
    v_mfma_f32_16x16x32_bf16 v[224:227], v[64:67], v[96:99], v[224:227]
    ds_read_b64_tr_b16 v[114:115], v14 offset:45568
    v_mfma_f32_16x16x32_bf16 v[228:231], v[68:71], v[96:99], v[228:231]
    ds_read_b64_tr_b16 v[116:117], v15 offset:45056
    v_mfma_f32_16x16x32_bf16 v[232:235], v[72:75], v[96:99], v[232:235]
    ds_read_b64_tr_b16 v[118:119], v15 offset:45568
    s_mul_i32 s36, s64, 1536
    s_add_u32 m0, s38, 90112
    v_mfma_f32_16x16x32_bf16 v[236:239], v[76:79], v[96:99], v[236:239]
    buffer_load_dwordx4 v8, s[12:15], s36 offen  lds
    ds_read_b128 v[124:127], v11 offset:51200
    v_mfma_f32_16x16x32_bf16 v[240:243], v[64:67], v[100:103], v[240:243]
    ds_read_b128 v[128:131], v11 offset:53248
    v_mfma_f32_16x16x32_bf16 v[244:247], v[68:71], v[100:103], v[244:247]
    ds_read_b128 v[132:135], v11 offset:55296
    v_mfma_f32_16x16x32_bf16 v[248:251], v[72:75], v[100:103], v[248:251]
    ds_read_b128 v[136:139], v11 offset:57344
    v_mfma_f32_16x16x32_bf16 v[252:255], v[76:79], v[100:103], v[252:255]
    ds_read_b128 v[140:143], v11 offset:59392
    s_waitcnt lgkmcnt(11)
    v_mfma_f32_16x16x32_bf16 v[160:163], v[104:107], v[120:123], v[160:163]
    s_waitcnt lgkmcnt(9)
    v_mfma_f32_16x16x32_bf16 v[164:167], v[108:111], v[120:123], v[164:167]
    buffer_load_dwordx4 v9, s[12:15], s36 offen offset:1024  lds
    v_mov_b32 v42, 0
    s_waitcnt lgkmcnt(7)
    v_mfma_f32_16x16x32_bf16 v[168:171], v[112:115], v[120:123], v[168:171]
    s_waitcnt lgkmcnt(5)
    v_mfma_f32_16x16x32_bf16 v[172:175], v[116:119], v[120:123], v[172:175]
    buffer_load_dwordx2 v[40:41], v42, s[28:31], 0 offen sc1
    s_waitcnt lgkmcnt(4)
    v_mfma_f32_16x16x32_bf16 v[176:179], v[104:107], v[124:127], v[176:179]
    v_mfma_f32_16x16x32_bf16 v[180:183], v[108:111], v[124:127], v[180:183]
    v_mfma_f32_16x16x32_bf16 v[184:187], v[112:115], v[124:127], v[184:187]
    v_mfma_f32_16x16x32_bf16 v[188:191], v[116:119], v[124:127], v[188:191]
    s_waitcnt lgkmcnt(3)
    v_mfma_f32_16x16x32_bf16 v[192:195], v[104:107], v[128:131], v[192:195]
    s_waitcnt lgkmcnt(0)
    v_mfma_f32_16x16x32_bf16 v[196:199], v[108:111], v[128:131], v[196:199]
    s_waitcnt vmcnt(13)
    s_barrier
    v_mfma_f32_16x16x32_bf16 v[200:203], v[112:115], v[128:131], v[200:203]
    ds_read_b128 v[80:83], v10 offset:0
    v_mfma_f32_16x16x32_bf16 v[204:207], v[116:119], v[128:131], v[204:207]
    ds_read_b64_tr_b16 v[64:65], v14 offset:0
    v_mfma_f32_16x16x32_bf16 v[208:211], v[104:107], v[132:135], v[208:211]
    ds_read_b64_tr_b16 v[66:67], v14 offset:512
    s_add_u32 m0, s37, 49152
    v_mfma_f32_16x16x32_bf16 v[212:215], v[108:111], v[132:135], v[212:215]
    buffer_load_dwordx4 v2, s[8:11], s65 offen  lds
    ds_read_b64_tr_b16 v[68:69], v15 offset:0
    v_mfma_f32_16x16x32_bf16 v[216:219], v[112:115], v[132:135], v[216:219]
    ds_read_b64_tr_b16 v[70:71], v15 offset:512
    v_mfma_f32_16x16x32_bf16 v[220:223], v[116:119], v[132:135], v[220:223]
    ds_read_b64_tr_b16 v[72:73], v14 offset:4096
    v_mfma_f32_16x16x32_bf16 v[224:227], v[104:107], v[136:139], v[224:227]
    buffer_load_dwordx4 v3, s[8:11], s65 offen offset:1024  lds
    ds_read_b64_tr_b16 v[74:75], v14 offset:4608
    v_mfma_f32_16x16x32_bf16 v[228:231], v[108:111], v[136:139], v[228:231]
    ds_read_b64_tr_b16 v[76:77], v15 offset:4096
    v_mfma_f32_16x16x32_bf16 v[232:235], v[112:115], v[136:139], v[232:235]
    ds_read_b64_tr_b16 v[78:79], v15 offset:4608
    v_mfma_f32_16x16x32_bf16 v[236:239], v[116:119], v[136:139], v[236:239]
    buffer_load_dwordx4 v4, s[8:11], s65 offen offset:2048  lds
    ds_read_b128 v[84:87], v10 offset:2048
    v_mfma_f32_16x16x32_bf16 v[240:243], v[104:107], v[140:143], v[240:243]
    ds_read_b128 v[88:91], v10 offset:4096
    v_mfma_f32_16x16x32_bf16 v[244:247], v[108:111], v[140:143], v[244:247]
    ds_read_b128 v[92:95], v10 offset:6144
    s_add_u32 s36, s36, 98304
    s_add_u32 m0, s38, 98304
    v_mfma_f32_16x16x32_bf16 v[248:251], v[112:115], v[140:143], v[248:251]
    buffer_load_dwordx4 v8, s[12:15], s36 offen  lds
    ds_read_b128 v[96:99], v10 offset:8192
    v_mfma_f32_16x16x32_bf16 v[252:255], v[116:119], v[140:143], v[252:255]
    ds_read_b128 v[100:103], v10 offset:10240
    s_waitcnt lgkmcnt(11)
    v_mfma_f32_16x16x32_bf16 v[160:163], v[64:67], v[80:83], v[160:163]
    s_waitcnt lgkmcnt(9)
    v_mfma_f32_16x16x32_bf16 v[164:167], v[68:71], v[80:83], v[164:167]
    buffer_load_dwordx4 v9, s[12:15], s36 offen offset:1024  lds
    s_waitcnt lgkmcnt(7)
    v_mfma_f32_16x16x32_bf16 v[168:171], v[72:75], v[80:83], v[168:171]
    s_waitcnt lgkmcnt(5)
    v_mfma_f32_16x16x32_bf16 v[172:175], v[76:79], v[80:83], v[172:175]
    s_add_u32 m0, s37, 52224
    s_waitcnt lgkmcnt(4)
    v_mfma_f32_16x16x32_bf16 v[176:179], v[64:67], v[84:87], v[176:179]
    buffer_load_dwordx4 v5, s[8:11], s65 offen  lds
    v_mfma_f32_16x16x32_bf16 v[180:183], v[68:71], v[84:87], v[180:183]
    v_mfma_f32_16x16x32_bf16 v[184:187], v[72:75], v[84:87], v[184:187]
    v_mfma_f32_16x16x32_bf16 v[188:191], v[76:79], v[84:87], v[188:191]
    buffer_load_dwordx4 v6, s[8:11], s65 offen offset:1024  lds
    s_waitcnt lgkmcnt(3)
    v_mfma_f32_16x16x32_bf16 v[192:195], v[64:67], v[88:91], v[192:195]
    s_waitcnt lgkmcnt(0)
    v_mfma_f32_16x16x32_bf16 v[196:199], v[68:71], v[88:91], v[196:199]
    s_waitcnt vmcnt(15)
    s_barrier
    v_mfma_f32_16x16x32_bf16 v[200:203], v[72:75], v[88:91], v[200:203]
    ds_read_b128 v[120:123], v11 offset:0
    v_mfma_f32_16x16x32_bf16 v[204:207], v[76:79], v[88:91], v[204:207]
    ds_read_b64_tr_b16 v[104:105], v14 offset:8192
    v_mfma_f32_16x16x32_bf16 v[208:211], v[64:67], v[92:95], v[208:211]
    ds_read_b64_tr_b16 v[106:107], v14 offset:8704
    v_mfma_f32_16x16x32_bf16 v[212:215], v[68:71], v[92:95], v[212:215]
    buffer_load_dwordx4 v7, s[8:11], s65 offen offset:2048  lds
    ds_read_b64_tr_b16 v[108:109], v15 offset:8192
    v_mfma_f32_16x16x32_bf16 v[216:219], v[72:75], v[92:95], v[216:219]
    ds_read_b64_tr_b16 v[110:111], v15 offset:8704
    v_mfma_f32_16x16x32_bf16 v[220:223], v[76:79], v[92:95], v[220:223]
    ds_read_b64_tr_b16 v[112:113], v14 offset:12288
    v_mfma_f32_16x16x32_bf16 v[224:227], v[64:67], v[96:99], v[224:227]
    ds_read_b64_tr_b16 v[114:115], v14 offset:12800
    v_mfma_f32_16x16x32_bf16 v[228:231], v[68:71], v[96:99], v[228:231]
    ds_read_b64_tr_b16 v[116:117], v15 offset:12288
    v_mfma_f32_16x16x32_bf16 v[232:235], v[72:75], v[96:99], v[232:235]
    ds_read_b64_tr_b16 v[118:119], v15 offset:12800
    s_mul_i32 s36, s65, 1536
    s_add_u32 m0, s38, 106496
    v_mfma_f32_16x16x32_bf16 v[236:239], v[76:79], v[96:99], v[236:239]
    buffer_load_dwordx4 v8, s[12:15], s36 offen  lds
    ds_read_b128 v[124:127], v11 offset:2048
    v_mfma_f32_16x16x32_bf16 v[240:243], v[64:67], v[100:103], v[240:243]
    ds_read_b128 v[128:131], v11 offset:4096
    v_mfma_f32_16x16x32_bf16 v[244:247], v[68:71], v[100:103], v[244:247]
    ds_read_b128 v[132:135], v11 offset:6144
    v_mfma_f32_16x16x32_bf16 v[248:251], v[72:75], v[100:103], v[248:251]
    ds_read_b128 v[136:139], v11 offset:8192
    v_mfma_f32_16x16x32_bf16 v[252:255], v[76:79], v[100:103], v[252:255]
    ds_read_b128 v[140:143], v11 offset:10240
    s_waitcnt lgkmcnt(11)
    v_mfma_f32_16x16x32_bf16 v[160:163], v[104:107], v[120:123], v[160:163]
    s_waitcnt lgkmcnt(9)
    v_mfma_f32_16x16x32_bf16 v[164:167], v[108:111], v[120:123], v[164:167]
    buffer_load_dwordx4 v9, s[12:15], s36 offen offset:1024  lds
    s_waitcnt lgkmcnt(7)
    v_mfma_f32_16x16x32_bf16 v[168:171], v[112:115], v[120:123], v[168:171]
    s_waitcnt lgkmcnt(5)
    v_mfma_f32_16x16x32_bf16 v[172:175], v[116:119], v[120:123], v[172:175]
    s_waitcnt lgkmcnt(4)
    v_mfma_f32_16x16x32_bf16 v[176:179], v[104:107], v[124:127], v[176:179]
    v_mfma_f32_16x16x32_bf16 v[180:183], v[108:111], v[124:127], v[180:183]
    v_mfma_f32_16x16x32_bf16 v[184:187], v[112:115], v[124:127], v[184:187]
    v_mfma_f32_16x16x32_bf16 v[188:191], v[116:119], v[124:127], v[188:191]
    s_waitcnt lgkmcnt(3)
    v_mfma_f32_16x16x32_bf16 v[192:195], v[104:107], v[128:131], v[192:195]
    s_waitcnt lgkmcnt(0)
    v_mfma_f32_16x16x32_bf16 v[196:199], v[108:111], v[128:131], v[196:199]
    s_waitcnt vmcnt(11)
    s_barrier
    v_mfma_f32_16x16x32_bf16 v[200:203], v[112:115], v[128:131], v[200:203]
    ds_read_b128 v[80:83], v10 offset:24576
    v_mfma_f32_16x16x32_bf16 v[204:207], v[116:119], v[128:131], v[204:207]
    ds_read_b64_tr_b16 v[64:65], v14 offset:16384
    v_mfma_f32_16x16x32_bf16 v[208:211], v[104:107], v[132:135], v[208:211]
    ds_read_b64_tr_b16 v[66:67], v14 offset:16896
    s_add_u32 m0, s37, 0
    v_mfma_f32_16x16x32_bf16 v[212:215], v[108:111], v[132:135], v[212:215]
    buffer_load_dwordx4 v2, s[8:11], s66 offen  lds
    ds_read_b64_tr_b16 v[68:69], v15 offset:16384
    v_mfma_f32_16x16x32_bf16 v[216:219], v[112:115], v[132:135], v[216:219]
    ds_read_b64_tr_b16 v[70:71], v15 offset:16896
    v_mfma_f32_16x16x32_bf16 v[220:223], v[116:119], v[132:135], v[220:223]
    ds_read_b64_tr_b16 v[72:73], v14 offset:20480
    v_mfma_f32_16x16x32_bf16 v[224:227], v[104:107], v[136:139], v[224:227]
    buffer_load_dwordx4 v3, s[8:11], s66 offen offset:1024  lds
    ds_read_b64_tr_b16 v[74:75], v14 offset:20992
    v_mfma_f32_16x16x32_bf16 v[228:231], v[108:111], v[136:139], v[228:231]
    ds_read_b64_tr_b16 v[76:77], v15 offset:20480
    v_mfma_f32_16x16x32_bf16 v[232:235], v[112:115], v[136:139], v[232:235]
    ds_read_b64_tr_b16 v[78:79], v15 offset:20992
    v_mfma_f32_16x16x32_bf16 v[236:239], v[116:119], v[136:139], v[236:239]
    buffer_load_dwordx4 v4, s[8:11], s66 offen offset:2048  lds
    ds_read_b128 v[84:87], v10 offset:26624
    v_mfma_f32_16x16x32_bf16 v[240:243], v[104:107], v[140:143], v[240:243]
    ds_read_b128 v[88:91], v10 offset:28672
    v_mfma_f32_16x16x32_bf16 v[244:247], v[108:111], v[140:143], v[244:247]
    ds_read_b128 v[92:95], v10 offset:30720
    s_add_u32 s36, s36, 98304
    s_add_u32 m0, s38, 114688
    v_mfma_f32_16x16x32_bf16 v[248:251], v[112:115], v[140:143], v[248:251]
    buffer_load_dwordx4 v8, s[12:15], s36 offen  lds
    ds_read_b128 v[96:99], v10 offset:32768
    v_mfma_f32_16x16x32_bf16 v[252:255], v[116:119], v[140:143], v[252:255]
    ds_read_b128 v[100:103], v10 offset:34816
    s_waitcnt lgkmcnt(11)
    v_mfma_f32_16x16x32_bf16 v[160:163], v[64:67], v[80:83], v[160:163]
    s_waitcnt lgkmcnt(9)
    v_mfma_f32_16x16x32_bf16 v[164:167], v[68:71], v[80:83], v[164:167]
    buffer_load_dwordx4 v9, s[12:15], s36 offen offset:1024  lds
    s_waitcnt vmcnt(15)
    v_cmp_ne_u32 vcc, 0, v40
    s_nop 1
    s_cbranch_vccnz L_tag_okA
    s_mov_b32 s5, 60000
L_tag_spinA:
    s_sleep 2
    buffer_load_dwordx2 v[40:41], v42, s[28:31], 0 offen sc1
    s_waitcnt vmcnt(0)
    v_cmp_ne_u32 vcc, 0, v40
    s_nop 1
    s_cbranch_vccnz L_tag_okA
    s_sub_u32 s5, s5, 1
    s_cmp_lg_u32 s5, 0
    s_cbranch_scc1 L_tag_spinA
L_tag_okA:
    v_mov_b32 v42, v40
    v_mov_b32 v43, v41
    s_waitcnt lgkmcnt(7)
    v_mfma_f32_16x16x32_bf16 v[168:171], v[72:75], v[80:83], v[168:171]
    s_waitcnt lgkmcnt(5)
    v_mfma_f32_16x16x32_bf16 v[172:175], v[76:79], v[80:83], v[172:175]
    v_cmp_gt_u32 vcc, 8, v1
    s_nop 1
    v_cndmask_b32 v44, 0, v40, vcc
    v_cndmask_b32 v45, 0, v41, vcc
    v_cndmask_b32 v46, 0, v42, vcc
    v_cndmask_b32 v47, 0, v43, vcc
    s_mov_b64 exec, 0xffff
    buffer_store_dwordx4 v[44:47], v38, s[20:23], 0 offen sc1
    s_mov_b64 exec, -1
    s_add_u32 m0, s37, 3072
    s_waitcnt lgkmcnt(4)
    v_mfma_f32_16x16x32_bf16 v[176:179], v[64:67], v[84:87], v[176:179]
    buffer_load_dwordx4 v5, s[8:11], s66 offen  lds
    v_mfma_f32_16x16x32_bf16 v[180:183], v[68:71], v[84:87], v[180:183]
    v_mfma_f32_16x16x32_bf16 v[184:187], v[72:75], v[84:87], v[184:187]
    v_mfma_f32_16x16x32_bf16 v[188:191], v[76:79], v[84:87], v[188:191]
    buffer_load_dwordx4 v6, s[8:11], s66 offen offset:1024  lds
    s_waitcnt lgkmcnt(3)
    v_mfma_f32_16x16x32_bf16 v[192:195], v[64:67], v[88:91], v[192:195]
    s_waitcnt lgkmcnt(0)
    v_mfma_f32_16x16x32_bf16 v[196:199], v[68:71], v[88:91], v[196:199]
    s_waitcnt vmcnt(13)
    s_barrier
    v_mfma_f32_16x16x32_bf16 v[200:203], v[72:75], v[88:91], v[200:203]
    ds_read_b128 v[120:123], v11 offset:24576
    v_mfma_f32_16x16x32_bf16 v[204:207], v[76:79], v[88:91], v[204:207]
    ds_read_b64_tr_b16 v[104:105], v14 offset:24576
    v_mfma_f32_16x16x32_bf16 v[208:211], v[64:67], v[92:95], v[208:211]
    ds_read_b64_tr_b16 v[106:107], v14 offset:25088
    v_mfma_f32_16x16x32_bf16 v[212:215], v[68:71], v[92:95], v[212:215]
    buffer_load_dwordx4 v7, s[8:11], s66 offen offset:2048  lds
    ds_read_b64_tr_b16 v[108:109], v15 offset:24576
    v_mfma_f32_16x16x32_bf16 v[216:219], v[72:75], v[92:95], v[216:219]
    ds_read_b64_tr_b16 v[110:111], v15 offset:25088
    v_mfma_f32_16x16x32_bf16 v[220:223], v[76:79], v[92:95], v[220:223]
    ds_read_b64_tr_b16 v[112:113], v14 offset:28672
    v_mfma_f32_16x16x32_bf16 v[224:227], v[64:67], v[96:99], v[224:227]
    ds_read_b64_tr_b16 v[114:115], v14 offset:29184
    v_mfma_f32_16x16x32_bf16 v[228:231], v[68:71], v[96:99], v[228:231]
    ds_read_b64_tr_b16 v[116:117], v15 offset:28672
    v_mfma_f32_16x16x32_bf16 v[232:235], v[72:75], v[96:99], v[232:235]
    ds_read_b64_tr_b16 v[118:119], v15 offset:29184
    s_mul_i32 s36, s66, 1536
    s_add_u32 m0, s38, 73728
    v_mfma_f32_16x16x32_bf16 v[236:239], v[76:79], v[96:99], v[236:239]
    buffer_load_dwordx4 v8, s[12:15], s36 offen  lds
    ds_read_b128 v[124:127], v11 offset:26624
    v_mfma_f32_16x16x32_bf16 v[240:243], v[64:67], v[100:103], v[240:243]
    ds_read_b128 v[128:131], v11 offset:28672
    v_mfma_f32_16x16x32_bf16 v[244:247], v[68:71], v[100:103], v[244:247]
    ds_read_b128 v[132:135], v11 offset:30720
    v_mfma_f32_16x16x32_bf16 v[248:251], v[72:75], v[100:103], v[248:251]
    ds_read_b128 v[136:139], v11 offset:32768
    v_mfma_f32_16x16x32_bf16 v[252:255], v[76:79], v[100:103], v[252:255]
    ds_read_b128 v[140:143], v11 offset:34816
    s_waitcnt lgkmcnt(11)
    v_mfma_f32_16x16x32_bf16 v[160:163], v[104:107], v[120:123], v[160:163]
    s_waitcnt lgkmcnt(9)
    v_mfma_f32_16x16x32_bf16 v[164:167], v[108:111], v[120:123], v[164:167]
    buffer_load_dwordx4 v9, s[12:15], s36 offen offset:1024  lds
    s_waitcnt lgkmcnt(7)
    v_mfma_f32_16x16x32_bf16 v[168:171], v[112:115], v[120:123], v[168:171]
    s_waitcnt lgkmcnt(5)
    v_mfma_f32_16x16x32_bf16 v[172:175], v[116:119], v[120:123], v[172:175]
    s_waitcnt lgkmcnt(4)
    v_mfma_f32_16x16x32_bf16 v[176:179], v[104:107], v[124:127], v[176:179]
    v_mfma_f32_16x16x32_bf16 v[180:183], v[108:111], v[124:127], v[180:183]
    v_mfma_f32_16x16x32_bf16 v[184:187], v[112:115], v[124:127], v[184:187]
    v_mfma_f32_16x16x32_bf16 v[188:191], v[116:119], v[124:127], v[188:191]
    s_waitcnt lgkmcnt(3)
    v_mfma_f32_16x16x32_bf16 v[192:195], v[104:107], v[128:131], v[192:195]
    s_waitcnt lgkmcnt(0)
    v_mfma_f32_16x16x32_bf16 v[196:199], v[108:111], v[128:131], v[196:199]
    s_waitcnt vmcnt(11)
    s_barrier
    v_mfma_f32_16x16x32_bf16 v[200:203], v[112:115], v[128:131], v[200:203]
    ds_read_b128 v[80:83], v10 offset:49152
    v_mfma_f32_16x16x32_bf16 v[204:207], v[116:119], v[128:131], v[204:207]
    ds_read_b64_tr_b16 v[64:65], v14 offset:32768
    v_mfma_f32_16x16x32_bf16 v[208:211], v[104:107], v[132:135], v[208:211]
    ds_read_b64_tr_b16 v[66:67], v14 offset:33280
    s_add_u32 m0, s37, 24576
    v_mfma_f32_16x16x32_bf16 v[212:215], v[108:111], v[132:135], v[212:215]
    buffer_load_dwordx4 v2, s[8:11], s67 offen  lds
    ds_read_b64_tr_b16 v[68:69], v15 offset:32768
    v_mfma_f32_16x16x32_bf16 v[216:219], v[112:115], v[132:135], v[216:219]
    ds_read_b64_tr_b16 v[70:71], v15 offset:33280
    v_mfma_f32_16x16x32_bf16 v[220:223], v[116:119], v[132:135], v[220:223]
    ds_read_b64_tr_b16 v[72:73], v14 offset:36864
    v_mfma_f32_16x16x32_bf16 v[224:227], v[104:107], v[136:139], v[224:227]
    buffer_load_dwordx4 v3, s[8:11], s67 offen offset:1024  lds
    ds_read_b64_tr_b16 v[74:75], v14 offset:37376
    v_mfma_f32_16x16x32_bf16 v[228:231], v[108:111], v[136:139], v[228:231]
    ds_read_b64_tr_b16 v[76:77], v15 offset:36864
    v_mfma_f32_16x16x32_bf16 v[232:235], v[112:115], v[136:139], v[232:235]
    ds_read_b64_tr_b16 v[78:79], v15 offset:37376
    v_mfma_f32_16x16x32_bf16 v[236:239], v[116:119], v[136:139], v[236:239]
    buffer_load_dwordx4 v4, s[8:11], s67 offen offset:2048  lds
    ds_read_b128 v[84:87], v10 offset:51200
    v_mfma_f32_16x16x32_bf16 v[240:243], v[104:107], v[140:143], v[240:243]
    ds_read_b128 v[88:91], v10 offset:53248
    v_mfma_f32_16x16x32_bf16 v[244:247], v[108:111], v[140:143], v[244:247]
    ds_read_b128 v[92:95], v10 offset:55296
    s_add_u32 s36, s36, 98304
    s_add_u32 m0, s38, 81920
    v_mfma_f32_16x16x32_bf16 v[248:251], v[112:115], v[140:143], v[248:251]
    buffer_load_dwordx4 v8, s[12:15], s36 offen  lds
    ds_read_b128 v[96:99], v10 offset:57344
    v_mfma_f32_16x16x32_bf16 v[252:255], v[116:119], v[140:143], v[252:255]
    ds_read_b128 v[100:103], v10 offset:59392
    s_waitcnt lgkmcnt(11)
    v_mfma_f32_16x16x32_bf16 v[160:163], v[64:67], v[80:83], v[160:163]
    s_waitcnt lgkmcnt(9)
    v_mfma_f32_16x16x32_bf16 v[164:167], v[68:71], v[80:83], v[164:167]
    buffer_load_dwordx4 v9, s[12:15], s36 offen offset:1024  lds
    s_waitcnt lgkmcnt(7)
    v_mfma_f32_16x16x32_bf16 v[168:171], v[72:75], v[80:83], v[168:171]
    s_waitcnt lgkmcnt(5)
    v_mfma_f32_16x16x32_bf16 v[172:175], v[76:79], v[80:83], v[172:175]
    s_add_u32 m0, s37, 27648
    s_waitcnt lgkmcnt(4)
    v_mfma_f32_16x16x32_bf16 v[176:179], v[64:67], v[84:87], v[176:179]
    buffer_load_dwordx4 v5, s[8:11], s67 offen  lds
    v_mfma_f32_16x16x32_bf16 v[180:183], v[68:71], v[84:87], v[180:183]
    v_mfma_f32_16x16x32_bf16 v[184:187], v[72:75], v[84:87], v[184:187]
    v_mfma_f32_16x16x32_bf16 v[188:191], v[76:79], v[84:87], v[188:191]
    buffer_load_dwordx4 v6, s[8:11], s67 offen offset:1024  lds
    s_waitcnt lgkmcnt(3)
    v_mfma_f32_16x16x32_bf16 v[192:195], v[64:67], v[88:91], v[192:195]
    s_waitcnt lgkmcnt(0)
    v_mfma_f32_16x16x32_bf16 v[196:199], v[68:71], v[88:91], v[196:199]
    s_waitcnt vmcnt(13)
    s_barrier
    v_mfma_f32_16x16x32_bf16 v[200:203], v[72:75], v[88:91], v[200:203]
    ds_read_b128 v[120:123], v11 offset:49152
    v_mfma_f32_16x16x32_bf16 v[204:207], v[76:79], v[88:91], v[204:207]
    ds_read_b64_tr_b16 v[104:105], v14 offset:40960
    v_mfma_f32_16x16x32_bf16 v[208:211], v[64:67], v[92:95], v[208:211]
    ds_read_b64_tr_b16 v[106:107], v14 offset:41472
    v_mfma_f32_16x16x32_bf16 v[212:215], v[68:71], v[92:95], v[212:215]
    buffer_load_dwordx4 v7, s[8:11], s67 offen offset:2048  lds
    ds_read_b64_tr_b16 v[108:109], v15 offset:40960
    v_mfma_f32_16x16x32_bf16 v[216:219], v[72:75], v[92:95], v[216:219]
    ds_read_b64_tr_b16 v[110:111], v15 offset:41472
    v_mfma_f32_16x16x32_bf16 v[220:223], v[76:79], v[92:95], v[220:223]
    ds_read_b64_tr_b16 v[112:113], v14 offset:45056
    v_mfma_f32_16x16x32_bf16 v[224:227], v[64:67], v[96:99], v[224:227]
    ds_read_b64_tr_b16 v[114:115], v14 offset:45568
    v_mfma_f32_16x16x32_bf16 v[228:231], v[68:71], v[96:99], v[228:231]
    ds_read_b64_tr_b16 v[116:117], v15 offset:45056
    v_mfma_f32_16x16x32_bf16 v[232:235], v[72:75], v[96:99], v[232:235]
    ds_read_b64_tr_b16 v[118:119], v15 offset:45568
    s_mul_i32 s36, s67, 1536
    s_add_u32 m0, s38, 90112
    v_mfma_f32_16x16x32_bf16 v[236:239], v[76:79], v[96:99], v[236:239]
    buffer_load_dwordx4 v8, s[12:15], s36 offen  lds
    ds_read_b128 v[124:127], v11 offset:51200
    v_mfma_f32_16x16x32_bf16 v[240:243], v[64:67], v[100:103], v[240:243]
    ds_read_b128 v[128:131], v11 offset:53248
    v_mfma_f32_16x16x32_bf16 v[244:247], v[68:71], v[100:103], v[244:247]
    ds_read_b128 v[132:135], v11 offset:55296
    v_mfma_f32_16x16x32_bf16 v[248:251], v[72:75], v[100:103], v[248:251]
    ds_read_b128 v[136:139], v11 offset:57344
    v_mfma_f32_16x16x32_bf16 v[252:255], v[76:79], v[100:103], v[252:255]
    ds_read_b128 v[140:143], v11 offset:59392
    s_waitcnt lgkmcnt(11)
    v_mfma_f32_16x16x32_bf16 v[160:163], v[104:107], v[120:123], v[160:163]
    s_waitcnt lgkmcnt(9)
    v_mfma_f32_16x16x32_bf16 v[164:167], v[108:111], v[120:123], v[164:167]
    buffer_load_dwordx4 v9, s[12:15], s36 offen offset:1024  lds
    s_waitcnt lgkmcnt(7)
    v_mfma_f32_16x16x32_bf16 v[168:171], v[112:115], v[120:123], v[168:171]
    s_waitcnt lgkmcnt(5)
    v_mfma_f32_16x16x32_bf16 v[172:175], v[116:119], v[120:123], v[172:175]
    s_waitcnt lgkmcnt(4)
    v_mfma_f32_16x16x32_bf16 v[176:179], v[104:107], v[124:127], v[176:179]
    v_mfma_f32_16x16x32_bf16 v[180:183], v[108:111], v[124:127], v[180:183]
    v_mfma_f32_16x16x32_bf16 v[184:187], v[112:115], v[124:127], v[184:187]
    v_mfma_f32_16x16x32_bf16 v[188:191], v[116:119], v[124:127], v[188:191]
    s_waitcnt lgkmcnt(3)
    v_mfma_f32_16x16x32_bf16 v[192:195], v[104:107], v[128:131], v[192:195]
    s_waitcnt lgkmcnt(0)
    v_mfma_f32_16x16x32_bf16 v[196:199], v[108:111], v[128:131], v[196:199]
    s_waitcnt vmcnt(10)
    s_barrier
    v_mfma_f32_16x16x32_bf16 v[200:203], v[112:115], v[128:131], v[200:203]
    ds_read_b128 v[80:83], v10 offset:0
    v_mfma_f32_16x16x32_bf16 v[204:207], v[116:119], v[128:131], v[204:207]
    ds_read_b64_tr_b16 v[64:65], v14 offset:0
    v_mfma_f32_16x16x32_bf16 v[208:211], v[104:107], v[132:135], v[208:211]
    ds_read_b64_tr_b16 v[66:67], v14 offset:512
    s_add_u32 m0, s37, 49152
    v_mfma_f32_16x16x32_bf16 v[212:215], v[108:111], v[132:135], v[212:215]
    buffer_load_dwordx4 v2, s[8:11], s68 offen  lds
    ds_read_b64_tr_b16 v[68:69], v15 offset:0
    v_mfma_f32_16x16x32_bf16 v[216:219], v[112:115], v[132:135], v[216:219]
    ds_read_b64_tr_b16 v[70:71], v15 offset:512
    v_mfma_f32_16x16x32_bf16 v[220:223], v[116:119], v[132:135], v[220:223]
    ds_read_b64_tr_b16 v[72:73], v14 offset:4096
    v_mfma_f32_16x16x32_bf16 v[224:227], v[104:107], v[136:139], v[224:227]
    buffer_load_dwordx4 v3, s[8:11], s68 offen offset:1024  lds
    ds_read_b64_tr_b16 v[74:75], v14 offset:4608
    v_mfma_f32_16x16x32_bf16 v[228:231], v[108:111], v[136:139], v[228:231]
    ds_read_b64_tr_b16 v[76:77], v15 offset:4096
    v_mfma_f32_16x16x32_bf16 v[232:235], v[112:115], v[136:139], v[232:235]
    ds_read_b64_tr_b16 v[78:79], v15 offset:4608
    v_mfma_f32_16x16x32_bf16 v[236:239], v[116:119], v[136:139], v[236:239]
    buffer_load_dwordx4 v4, s[8:11], s68 offen offset:2048  lds
    ds_read_b128 v[84:87], v10 offset:2048
    v_mfma_f32_16x16x32_bf16 v[240:243], v[104:107], v[140:143], v[240:243]
    ds_read_b128 v[88:91], v10 offset:4096
    v_mfma_f32_16x16x32_bf16 v[244:247], v[108:111], v[140:143], v[244:247]
    ds_read_b128 v[92:95], v10 offset:6144
    s_add_u32 s36, s36, 98304
    s_add_u32 m0, s38, 98304
    v_mfma_f32_16x16x32_bf16 v[248:251], v[112:115], v[140:143], v[248:251]
    buffer_load_dwordx4 v8, s[12:15], s36 offen  lds
    ds_read_b128 v[96:99], v10 offset:8192
    v_mfma_f32_16x16x32_bf16 v[252:255], v[116:119], v[140:143], v[252:255]
    ds_read_b128 v[100:103], v10 offset:10240
    s_waitcnt lgkmcnt(11)
    v_mfma_f32_16x16x32_bf16 v[160:163], v[64:67], v[80:83], v[160:163]
    s_waitcnt lgkmcnt(9)
    v_mfma_f32_16x16x32_bf16 v[164:167], v[68:71], v[80:83], v[164:167]
    buffer_load_dwordx4 v9, s[12:15], s36 offen offset:1024  lds
    s_waitcnt lgkmcnt(7)
    v_mfma_f32_16x16x32_bf16 v[168:171], v[72:75], v[80:83], v[168:171]
    s_waitcnt lgkmcnt(5)
    v_mfma_f32_16x16x32_bf16 v[172:175], v[76:79], v[80:83], v[172:175]
    s_add_u32 m0, s37, 52224
    s_waitcnt lgkmcnt(4)
    v_mfma_f32_16x16x32_bf16 v[176:179], v[64:67], v[84:87], v[176:179]
    buffer_load_dwordx4 v5, s[8:11], s68 offen  lds
    v_mfma_f32_16x16x32_bf16 v[180:183], v[68:71], v[84:87], v[180:183]
    v_mfma_f32_16x16x32_bf16 v[184:187], v[72:75], v[84:87], v[184:187]
    v_mfma_f32_16x16x32_bf16 v[188:191], v[76:79], v[84:87], v[188:191]
    buffer_load_dwordx4 v6, s[8:11], s68 offen offset:1024  lds
    buffer_load_dwordx2 v[152:153], v37, s[20:23], 0 offen sc1
    s_waitcnt lgkmcnt(3)
    v_mfma_f32_16x16x32_bf16 v[192:195], v[64:67], v[88:91], v[192:195]
    s_waitcnt lgkmcnt(0)
    v_mfma_f32_16x16x32_bf16 v[196:199], v[68:71], v[88:91], v[196:199]
    s_waitcnt vmcnt(13)
    s_barrier
    v_mfma_f32_16x16x32_bf16 v[200:203], v[72:75], v[88:91], v[200:203]
    ds_read_b128 v[120:123], v11 offset:0
    v_mfma_f32_16x16x32_bf16 v[204:207], v[76:79], v[88:91], v[204:207]
    ds_read_b64_tr_b16 v[104:105], v14 offset:8192
    v_mfma_f32_16x16x32_bf16 v[208:211], v[64:67], v[92:95], v[208:211]
    ds_read_b64_tr_b16 v[106:107], v14 offset:8704
    v_mfma_f32_16x16x32_bf16 v[212:215], v[68:71], v[92:95], v[212:215]
    buffer_load_dwordx4 v7, s[8:11], s68 offen offset:2048  lds
    ds_read_b64_tr_b16 v[108:109], v15 offset:8192
    v_mfma_f32_16x16x32_bf16 v[216:219], v[72:75], v[92:95], v[216:219]
    ds_read_b64_tr_b16 v[110:111], v15 offset:8704
    v_mfma_f32_16x16x32_bf16 v[220:223], v[76:79], v[92:95], v[220:223]
    ds_read_b64_tr_b16 v[112:113], v14 offset:12288
    v_mfma_f32_16x16x32_bf16 v[224:227], v[64:67], v[96:99], v[224:227]
    ds_read_b64_tr_b16 v[114:115], v14 offset:12800
    v_mfma_f32_16x16x32_bf16 v[228:231], v[68:71], v[96:99], v[228:231]
    ds_read_b64_tr_b16 v[116:117], v15 offset:12288
    v_mfma_f32_16x16x32_bf16 v[232:235], v[72:75], v[96:99], v[232:235]
    ds_read_b64_tr_b16 v[118:119], v15 offset:12800
    s_mul_i32 s36, s68, 1536
    s_add_u32 m0, s38, 106496
    v_mfma_f32_16x16x32_bf16 v[236:239], v[76:79], v[96:99], v[236:239]
    buffer_load_dwordx4 v8, s[12:15], s36 offen  lds
    ds_read_b128 v[124:127], v11 offset:2048
    v_mfma_f32_16x16x32_bf16 v[240:243], v[64:67], v[100:103], v[240:243]
    ds_read_b128 v[128:131], v11 offset:4096
    v_mfma_f32_16x16x32_bf16 v[244:247], v[68:71], v[100:103], v[244:247]
    ds_read_b128 v[132:135], v11 offset:6144
    v_mfma_f32_16x16x32_bf16 v[248:251], v[72:75], v[100:103], v[248:251]
    ds_read_b128 v[136:139], v11 offset:8192
    v_mfma_f32_16x16x32_bf16 v[252:255], v[76:79], v[100:103], v[252:255]
    ds_read_b128 v[140:143], v11 offset:10240
    s_waitcnt lgkmcnt(11)
    v_mfma_f32_16x16x32_bf16 v[160:163], v[104:107], v[120:123], v[160:163]
    s_waitcnt lgkmcnt(9)
    v_mfma_f32_16x16x32_bf16 v[164:167], v[108:111], v[120:123], v[164:167]
    buffer_load_dwordx4 v9, s[12:15], s36 offen offset:1024  lds
    s_waitcnt lgkmcnt(7)
    v_mfma_f32_16x16x32_bf16 v[168:171], v[112:115], v[120:123], v[168:171]
    s_waitcnt lgkmcnt(5)
    v_mfma_f32_16x16x32_bf16 v[172:175], v[116:119], v[120:123], v[172:175]
    s_waitcnt lgkmcnt(4)
    v_mfma_f32_16x16x32_bf16 v[176:179], v[104:107], v[124:127], v[176:179]
    v_mfma_f32_16x16x32_bf16 v[180:183], v[108:111], v[124:127], v[180:183]
    v_mfma_f32_16x16x32_bf16 v[184:187], v[112:115], v[124:127], v[184:187]
    v_mfma_f32_16x16x32_bf16 v[188:191], v[116:119], v[124:127], v[188:191]
    s_waitcnt lgkmcnt(3)
    v_mfma_f32_16x16x32_bf16 v[192:195], v[104:107], v[128:131], v[192:195]
    s_waitcnt lgkmcnt(0)
    v_mfma_f32_16x16x32_bf16 v[196:199], v[108:111], v[128:131], v[196:199]
    s_waitcnt vmcnt(11)
    s_barrier
    v_mfma_f32_16x16x32_bf16 v[200:203], v[112:115], v[128:131], v[200:203]
    ds_read_b128 v[80:83], v10 offset:24576
    v_mfma_f32_16x16x32_bf16 v[204:207], v[116:119], v[128:131], v[204:207]
    ds_read_b64_tr_b16 v[64:65], v14 offset:16384
    v_mfma_f32_16x16x32_bf16 v[208:211], v[104:107], v[132:135], v[208:211]
    ds_read_b64_tr_b16 v[66:67], v14 offset:16896
    s_add_u32 m0, s37, 0
    v_mfma_f32_16x16x32_bf16 v[212:215], v[108:111], v[132:135], v[212:215]
    buffer_load_dwordx4 v2, s[8:11], s69 offen  lds
    ds_read_b64_tr_b16 v[68:69], v15 offset:16384
    v_mfma_f32_16x16x32_bf16 v[216:219], v[112:115], v[132:135], v[216:219]
    ds_read_b64_tr_b16 v[70:71], v15 offset:16896
    v_mfma_f32_16x16x32_bf16 v[220:223], v[116:119], v[132:135], v[220:223]
    ds_read_b64_tr_b16 v[72:73], v14 offset:20480
    v_mfma_f32_16x16x32_bf16 v[224:227], v[104:107], v[136:139], v[224:227]
    buffer_load_dwordx4 v3, s[8:11], s69 offen offset:1024  lds
    ds_read_b64_tr_b16 v[74:75], v14 offset:20992
    v_mfma_f32_16x16x32_bf16 v[228:231], v[108:111], v[136:139], v[228:231]
    ds_read_b64_tr_b16 v[76:77], v15 offset:20480
    v_mfma_f32_16x16x32_bf16 v[232:235], v[112:115], v[136:139], v[232:235]
    ds_read_b64_tr_b16 v[78:79], v15 offset:20992
    v_mfma_f32_16x16x32_bf16 v[236:239], v[116:119], v[136:139], v[236:239]
    buffer_load_dwordx4 v4, s[8:11], s69 offen offset:2048  lds
    ds_read_b128 v[84:87], v10 offset:26624
    v_mfma_f32_16x16x32_bf16 v[240:243], v[104:107], v[140:143], v[240:243]
    ds_read_b128 v[88:91], v10 offset:28672
    v_mfma_f32_16x16x32_bf16 v[244:247], v[108:111], v[140:143], v[244:247]
    ds_read_b128 v[92:95], v10 offset:30720
    s_add_u32 s36, s36, 98304
    s_add_u32 m0, s38, 114688
    v_mfma_f32_16x16x32_bf16 v[248:251], v[112:115], v[140:143], v[248:251]
    buffer_load_dwordx4 v8, s[12:15], s36 offen  lds
    ds_read_b128 v[96:99], v10 offset:32768
    v_mfma_f32_16x16x32_bf16 v[252:255], v[116:119], v[140:143], v[252:255]
    ds_read_b128 v[100:103], v10 offset:34816
    s_waitcnt lgkmcnt(11)
    v_mfma_f32_16x16x32_bf16 v[160:163], v[64:67], v[80:83], v[160:163]
    s_waitcnt lgkmcnt(9)
    v_mfma_f32_16x16x32_bf16 v[164:167], v[68:71], v[80:83], v[164:167]
    buffer_load_dwordx4 v9, s[12:15], s36 offen offset:1024  lds
    s_waitcnt lgkmcnt(7)
    v_mfma_f32_16x16x32_bf16 v[168:171], v[72:75], v[80:83], v[168:171]
    s_waitcnt lgkmcnt(5)
    v_mfma_f32_16x16x32_bf16 v[172:175], v[76:79], v[80:83], v[172:175]
    s_add_u32 m0, s37, 3072
    s_waitcnt lgkmcnt(4)
    v_mfma_f32_16x16x32_bf16 v[176:179], v[64:67], v[84:87], v[176:179]
    buffer_load_dwordx4 v5, s[8:11], s69 offen  lds
    v_mfma_f32_16x16x32_bf16 v[180:183], v[68:71], v[84:87], v[180:183]
    v_mfma_f32_16x16x32_bf16 v[184:187], v[72:75], v[84:87], v[184:187]
    v_mfma_f32_16x16x32_bf16 v[188:191], v[76:79], v[84:87], v[188:191]
    buffer_load_dwordx4 v6, s[8:11], s69 offen offset:1024  lds
    s_waitcnt vmcnt(10)
    v_cmp_ne_u64 vcc, v[152:153], v[40:41]
    s_nop 1
    s_cbranch_vccz L_zfA_ok
    s_mov_b32 s5, 60000
L_zfA_spin:
    s_sleep 1
    buffer_load_dwordx2 v[152:153], v37, s[20:23], 0 offen sc1
    s_waitcnt vmcnt(0)
    v_cmp_ne_u64 vcc, v[152:153], v[40:41]
    s_nop 1
    s_cbranch_vccz L_zfA_ok
    s_sub_u32 s5, s5, 1
    s_cmp_lg_u32 s5, 0
    s_cbranch_scc1 L_zfA_spin
L_zfA_ok:
    s_waitcnt lgkmcnt(3)
    v_mfma_f32_16x16x32_bf16 v[192:195], v[64:67], v[88:91], v[192:195]
    s_waitcnt lgkmcnt(0)
    v_mfma_f32_16x16x32_bf16 v[196:199], v[68:71], v[88:91], v[196:199]
    s_barrier
    v_mfma_f32_16x16x32_bf16 v[200:203], v[72:75], v[88:91], v[200:203]
    ds_read_b128 v[120:123], v11 offset:24576
    v_mfma_f32_16x16x32_bf16 v[204:207], v[76:79], v[88:91], v[204:207]
    ds_read_b64_tr_b16 v[104:105], v14 offset:24576
    v_mfma_f32_16x16x32_bf16 v[208:211], v[64:67], v[92:95], v[208:211]
    ds_read_b64_tr_b16 v[106:107], v14 offset:25088
    v_mfma_f32_16x16x32_bf16 v[212:215], v[68:71], v[92:95], v[212:215]
    buffer_load_dwordx4 v7, s[8:11], s69 offen offset:2048  lds
    ds_read_b64_tr_b16 v[108:109], v15 offset:24576
    v_mfma_f32_16x16x32_bf16 v[216:219], v[72:75], v[92:95], v[216:219]
    ds_read_b64_tr_b16 v[110:111], v15 offset:25088
    v_mfma_f32_16x16x32_bf16 v[220:223], v[76:79], v[92:95], v[220:223]
    ds_read_b64_tr_b16 v[112:113], v14 offset:28672
    v_mfma_f32_16x16x32_bf16 v[224:227], v[64:67], v[96:99], v[224:227]
    ds_read_b64_tr_b16 v[114:115], v14 offset:29184
    v_mfma_f32_16x16x32_bf16 v[228:231], v[68:71], v[96:99], v[228:231]
    ds_read_b64_tr_b16 v[116:117], v15 offset:28672
    v_mfma_f32_16x16x32_bf16 v[232:235], v[72:75], v[96:99], v[232:235]
    ds_read_b64_tr_b16 v[118:119], v15 offset:29184
    s_mul_i32 s36, s69, 1536
    s_add_u32 m0, s38, 73728
    v_mfma_f32_16x16x32_bf16 v[236:239], v[76:79], v[96:99], v[236:239]
    buffer_load_dwordx4 v8, s[12:15], s36 offen  lds
    ds_read_b128 v[124:127], v11 offset:26624
    v_mfma_f32_16x16x32_bf16 v[240:243], v[64:67], v[100:103], v[240:243]
    ds_read_b128 v[128:131], v11 offset:28672
    v_mfma_f32_16x16x32_bf16 v[244:247], v[68:71], v[100:103], v[244:247]
    ds_read_b128 v[132:135], v11 offset:30720
    v_mfma_f32_16x16x32_bf16 v[248:251], v[72:75], v[100:103], v[248:251]
    ds_read_b128 v[136:139], v11 offset:32768
    v_mfma_f32_16x16x32_bf16 v[252:255], v[76:79], v[100:103], v[252:255]
    ds_read_b128 v[140:143], v11 offset:34816
    s_waitcnt lgkmcnt(11)
    v_mfma_f32_16x16x32_bf16 v[160:163], v[104:107], v[120:123], v[160:163]
    s_waitcnt lgkmcnt(9)
    v_mfma_f32_16x16x32_bf16 v[164:167], v[108:111], v[120:123], v[164:167]
    buffer_load_dwordx4 v9, s[12:15], s36 offen offset:1024  lds
    s_waitcnt lgkmcnt(7)
    v_mfma_f32_16x16x32_bf16 v[168:171], v[112:115], v[120:123], v[168:171]
    s_waitcnt lgkmcnt(5)
    v_mfma_f32_16x16x32_bf16 v[172:175], v[116:119], v[120:123], v[172:175]
    s_add_u32 s36, s36, 98304
    s_add_u32 m0, s38, 81920
    s_waitcnt lgkmcnt(4)
    v_mfma_f32_16x16x32_bf16 v[176:179], v[104:107], v[124:127], v[176:179]
    buffer_load_dwordx4 v8, s[12:15], s36 offen  lds
    v_mfma_f32_16x16x32_bf16 v[180:183], v[108:111], v[124:127], v[180:183]
    v_mfma_f32_16x16x32_bf16 v[184:187], v[112:115], v[124:127], v[184:187]
    v_mfma_f32_16x16x32_bf16 v[188:191], v[116:119], v[124:127], v[188:191]
    buffer_load_dwordx4 v9, s[12:15], s36 offen offset:1024  lds
    s_waitcnt lgkmcnt(3)
    v_mfma_f32_16x16x32_bf16 v[192:195], v[104:107], v[128:131], v[192:195]
    s_waitcnt lgkmcnt(0)
    v_mfma_f32_16x16x32_bf16 v[196:199], v[108:111], v[128:131], v[196:199]
    s_waitcnt vmcnt(12)
    s_barrier
    v_mfma_f32_16x16x32_bf16 v[200:203], v[112:115], v[128:131], v[200:203]
    ds_read_b128 v[80:83], v10 offset:49152
    v_mfma_f32_16x16x32_bf16 v[204:207], v[116:119], v[128:131], v[204:207]
    ds_read_b64_tr_b16 v[64:65], v14 offset:32768
    v_mfma_f32_16x16x32_bf16 v[208:211], v[104:107], v[132:135], v[208:211]
    ds_read_b64_tr_b16 v[66:67], v14 offset:33280
    v_mfma_f32_16x16x32_bf16 v[212:215], v[108:111], v[132:135], v[212:215]
    buffer_load_dwordx4 a[0:3], v20, s[20:23], s39 offen sc1
    ds_read_b64_tr_b16 v[68:69], v15 offset:32768
    v_mfma_f32_16x16x32_bf16 v[216:219], v[112:115], v[132:135], v[216:219]
    ds_read_b64_tr_b16 v[70:71], v15 offset:33280
    v_mfma_f32_16x16x32_bf16 v[220:223], v[116:119], v[132:135], v[220:223]
    ds_read_b64_tr_b16 v[72:73], v14 offset:36864
    v_mfma_f32_16x16x32_bf16 v[224:227], v[104:107], v[136:139], v[224:227]
    buffer_load_dwordx4 a[4:7], v20, s[20:23], s39 offen offset:1024 sc1
    ds_read_b64_tr_b16 v[74:75], v14 offset:37376
    v_mfma_f32_16x16x32_bf16 v[228:231], v[108:111], v[136:139], v[228:231]
    ds_read_b64_tr_b16 v[76:77], v15 offset:36864
    v_mfma_f32_16x16x32_bf16 v[232:235], v[112:115], v[136:139], v[232:235]
    ds_read_b64_tr_b16 v[78:79], v15 offset:37376
    v_mfma_f32_16x16x32_bf16 v[236:239], v[116:119], v[136:139], v[236:239]
    buffer_load_dwordx4 a[8:11], v20, s[20:23], s39 offen offset:2048 sc1
    ds_read_b128 v[84:87], v10 offset:51200
    v_mfma_f32_16x16x32_bf16 v[240:243], v[104:107], v[140:143], v[240:243]
    ds_read_b128 v[88:91], v10 offset:53248
    v_mfma_f32_16x16x32_bf16 v[244:247], v[108:111], v[140:143], v[244:247]
    ds_read_b128 v[92:95], v10 offset:55296
    v_mfma_f32_16x16x32_bf16 v[248:251], v[112:115], v[140:143], v[248:251]
    ds_read_b128 v[96:99], v10 offset:57344
    v_mfma_f32_16x16x32_bf16 v[252:255], v[116:119], v[140:143], v[252:255]
    ds_read_b128 v[100:103], v10 offset:59392
    s_waitcnt lgkmcnt(11)
    v_mfma_f32_16x16x32_bf16 v[160:163], v[64:67], v[80:83], v[160:163]
    s_waitcnt lgkmcnt(9)
    v_mfma_f32_16x16x32_bf16 v[164:167], v[68:71], v[80:83], v[164:167]
    buffer_load_dwordx4 a[12:15], v20, s[20:23], s39 offen offset:3072 sc1
    s_waitcnt lgkmcnt(7)
    v_mfma_f32_16x16x32_bf16 v[168:171], v[72:75], v[80:83], v[168:171]
    s_waitcnt lgkmcnt(5)
    v_mfma_f32_16x16x32_bf16 v[172:175], v[76:79], v[80:83], v[172:175]
    s_waitcnt lgkmcnt(4)
    v_mfma_f32_16x16x32_bf16 v[176:179], v[64:67], v[84:87], v[176:179]
    buffer_load_dwordx4 a[16:19], v21, s[20:23], s39 offen sc1
    v_mfma_f32_16x16x32_bf16 v[180:183], v[68:71], v[84:87], v[180:183]
    v_mfma_f32_16x16x32_bf16 v[184:187], v[72:75], v[84:87], v[184:187]
    s_add_u32 s39, s39, 5120
    s_sub_u32 s49, s39, 61440
    s_cmp_eq_u32 s39, s40
    s_cselect_b32 s39, s49, s39
    v_mfma_f32_16x16x32_bf16 v[188:191], v[76:79], v[84:87], v[188:191]
    buffer_load_dwordx4 a[20:23], v20, s[20:23], s39 offen sc1
    s_waitcnt lgkmcnt(3)
    v_mfma_f32_16x16x32_bf16 v[192:195], v[64:67], v[88:91], v[192:195]
    s_waitcnt lgkmcnt(0)
    v_mfma_f32_16x16x32_bf16 v[196:199], v[68:71], v[88:91], v[196:199]
    s_waitcnt vmcnt(13)
    s_barrier
    v_mfma_f32_16x16x32_bf16 v[200:203], v[72:75], v[88:91], v[200:203]
    ds_read_b128 v[120:123], v11 offset:49152
    v_mfma_f32_16x16x32_bf16 v[204:207], v[76:79], v[88:91], v[204:207]
    ds_read_b64_tr_b16 v[104:105], v14 offset:40960
    v_mfma_f32_16x16x32_bf16 v[208:211], v[64:67], v[92:95], v[208:211]
    ds_read_b64_tr_b16 v[106:107], v14 offset:41472
    v_mfma_f32_16x16x32_bf16 v[212:215], v[68:71], v[92:95], v[212:215]
    buffer_load_dwordx4 a[24:27], v20, s[20:23], s39 offen offset:1024 sc1
    ds_read_b64_tr_b16 v[108:109], v15 offset:40960
    v_mfma_f32_16x16x32_bf16 v[216:219], v[72:75], v[92:95], v[216:219]
    ds_read_b64_tr_b16 v[110:111], v15 offset:41472
    v_mfma_f32_16x16x32_bf16 v[220:223], v[76:79], v[92:95], v[220:223]
    ds_read_b64_tr_b16 v[112:113], v14 offset:45056
    v_mfma_f32_16x16x32_bf16 v[224:227], v[64:67], v[96:99], v[224:227]
    buffer_load_dwordx4 a[28:31], v20, s[20:23], s39 offen offset:2048 sc1
    ds_read_b64_tr_b16 v[114:115], v14 offset:45568
    v_mfma_f32_16x16x32_bf16 v[228:231], v[68:71], v[96:99], v[228:231]
    ds_read_b64_tr_b16 v[116:117], v15 offset:45056
    v_mfma_f32_16x16x32_bf16 v[232:235], v[72:75], v[96:99], v[232:235]
    ds_read_b64_tr_b16 v[118:119], v15 offset:45568
    v_mfma_f32_16x16x32_bf16 v[236:239], v[76:79], v[96:99], v[236:239]
    buffer_load_dwordx4 a[32:35], v20, s[20:23], s39 offen offset:3072 sc1
    ds_read_b128 v[124:127], v11 offset:51200
    v_mfma_f32_16x16x32_bf16 v[240:243], v[64:67], v[100:103], v[240:243]
    ds_read_b128 v[128:131], v11 offset:53248
    v_mfma_f32_16x16x32_bf16 v[244:247], v[68:71], v[100:103], v[244:247]
    ds_read_b128 v[132:135], v11 offset:55296
    v_mfma_f32_16x16x32_bf16 v[248:251], v[72:75], v[100:103], v[248:251]
    ds_read_b128 v[136:139], v11 offset:57344
    v_mfma_f32_16x16x32_bf16 v[252:255], v[76:79], v[100:103], v[252:255]
    ds_read_b128 v[140:143], v11 offset:59392
    s_waitcnt lgkmcnt(11)
    v_mfma_f32_16x16x32_bf16 v[160:163], v[104:107], v[120:123], v[160:163]
    s_waitcnt lgkmcnt(9)
    v_mfma_f32_16x16x32_bf16 v[164:167], v[108:111], v[120:123], v[164:167]
    buffer_load_dwordx4 a[36:39], v21, s[20:23], s39 offen sc1
    s_waitcnt lgkmcnt(7)
    v_mfma_f32_16x16x32_bf16 v[168:171], v[112:115], v[120:123], v[168:171]
    s_waitcnt lgkmcnt(5)
    v_mfma_f32_16x16x32_bf16 v[172:175], v[116:119], v[120:123], v[172:175]
    s_add_u32 s39, s39, 5120
    s_sub_u32 s49, s39, 61440
    s_cmp_eq_u32 s39, s40
    s_cselect_b32 s39, s49, s39
    s_waitcnt lgkmcnt(4)
    v_mfma_f32_16x16x32_bf16 v[176:179], v[104:107], v[124:127], v[176:179]
    buffer_load_dwordx4 a[40:43], v20, s[20:23], s39 offen sc1
    v_mfma_f32_16x16x32_bf16 v[180:183], v[108:111], v[124:127], v[180:183]
    v_mfma_f32_16x16x32_bf16 v[184:187], v[112:115], v[124:127], v[184:187]
    v_mfma_f32_16x16x32_bf16 v[188:191], v[116:119], v[124:127], v[188:191]
    buffer_load_dwordx4 a[44:47], v20, s[20:23], s39 offen offset:1024 sc1
    s_waitcnt lgkmcnt(3)
    v_mfma_f32_16x16x32_bf16 v[192:195], v[104:107], v[128:131], v[192:195]
    s_waitcnt lgkmcnt(0)
    v_mfma_f32_16x16x32_bf16 v[196:199], v[108:111], v[128:131], v[196:199]
    s_waitcnt vmcnt(14)
    s_barrier
    v_mfma_f32_16x16x32_bf16 v[200:203], v[112:115], v[128:131], v[200:203]
    ds_read_b128 v[80:83], v10 offset:0
    v_mfma_f32_16x16x32_bf16 v[204:207], v[116:119], v[128:131], v[204:207]
    ds_read_b64_tr_b16 v[64:65], v14 offset:0
    v_mfma_f32_16x16x32_bf16 v[208:211], v[104:107], v[132:135], v[208:211]
    ds_read_b64_tr_b16 v[66:67], v14 offset:512
    v_mfma_f32_16x16x32_bf16 v[212:215], v[108:111], v[132:135], v[212:215]
    buffer_load_dwordx4 a[48:51], v20, s[20:23], s39 offen offset:2048 sc1
    ds_read_b64_tr_b16 v[68:69], v15 offset:0
    v_mfma_f32_16x16x32_bf16 v[216:219], v[112:115], v[132:135], v[216:219]
    ds_read_b64_tr_b16 v[70:71], v15 offset:512
    v_mfma_f32_16x16x32_bf16 v[220:223], v[116:119], v[132:135], v[220:223]
    ds_read_b64_tr_b16 v[72:73], v14 offset:4096
    v_mfma_f32_16x16x32_bf16 v[224:227], v[104:107], v[136:139], v[224:227]
    buffer_load_dwordx4 a[52:55], v20, s[20:23], s39 offen offset:3072 sc1
    ds_read_b64_tr_b16 v[74:75], v14 offset:4608
    v_mfma_f32_16x16x32_bf16 v[228:231], v[108:111], v[136:139], v[228:231]
    ds_read_b64_tr_b16 v[76:77], v15 offset:4096
    v_mfma_f32_16x16x32_bf16 v[232:235], v[112:115], v[136:139], v[232:235]
    ds_read_b64_tr_b16 v[78:79], v15 offset:4608
    v_mfma_f32_16x16x32_bf16 v[236:239], v[116:119], v[136:139], v[236:239]
    buffer_load_dwordx4 a[56:59], v21, s[20:23], s39 offen sc1
    ds_read_b128 v[84:87], v10 offset:2048
    v_mfma_f32_16x16x32_bf16 v[240:243], v[104:107], v[140:143], v[240:243]
    ds_read_b128 v[88:91], v10 offset:4096
    v_mfma_f32_16x16x32_bf16 v[244:247], v[108:111], v[140:143], v[244:247]
    ds_read_b128 v[92:95], v10 offset:6144
    v_mfma_f32_16x16x32_bf16 v[248:251], v[112:115], v[140:143], v[248:251]
    ds_read_b128 v[96:99], v10 offset:8192
    v_mfma_f32_16x16x32_bf16 v[252:255], v[116:119], v[140:143], v[252:255]
    ds_read_b128 v[100:103], v10 offset:10240
    s_waitcnt lgkmcnt(11)
    v_mfma_f32_16x16x32_bf16 v[160:163], v[64:67], v[80:83], v[160:163]
    s_add_u32 s39, s39, 5120
    s_sub_u32 s49, s39, 61440
    s_cmp_eq_u32 s39, s40
    s_cselect_b32 s39, s49, s39
    s_waitcnt lgkmcnt(9)
    v_mfma_f32_16x16x32_bf16 v[164:167], v[68:71], v[80:83], v[164:167]
    buffer_load_dwordx4 a[60:63], v20, s[20:23], s39 offen sc1
    s_waitcnt lgkmcnt(7)
    v_mfma_f32_16x16x32_bf16 v[168:171], v[72:75], v[80:83], v[168:171]
    s_waitcnt lgkmcnt(5)
    v_mfma_f32_16x16x32_bf16 v[172:175], v[76:79], v[80:83], v[172:175]
    s_waitcnt lgkmcnt(4)
    v_mfma_f32_16x16x32_bf16 v[176:179], v[64:67], v[84:87], v[176:179]
    buffer_load_dwordx4 a[64:67], v20, s[20:23], s39 offen offset:1024 sc1
    v_mfma_f32_16x16x32_bf16 v[180:183], v[68:71], v[84:87], v[180:183]
    v_mfma_f32_16x16x32_bf16 v[184:187], v[72:75], v[84:87], v[184:187]
    v_mfma_f32_16x16x32_bf16 v[188:191], v[76:79], v[84:87], v[188:191]
    buffer_load_dwordx4 a[68:71], v20, s[20:23], s39 offen offset:2048 sc1
    s_waitcnt lgkmcnt(3)
    v_mfma_f32_16x16x32_bf16 v[192:195], v[64:67], v[88:91], v[192:195]
    s_waitcnt lgkmcnt(0)
    v_mfma_f32_16x16x32_bf16 v[196:199], v[68:71], v[88:91], v[196:199]
    s_waitcnt vmcnt(18)
    s_barrier
    v_mfma_f32_16x16x32_bf16 v[200:203], v[72:75], v[88:91], v[200:203]
    ds_read_b128 v[120:123], v11 offset:0
    v_mfma_f32_16x16x32_bf16 v[204:207], v[76:79], v[88:91], v[204:207]
    ds_read_b64_tr_b16 v[104:105], v14 offset:8192
    v_mfma_f32_16x16x32_bf16 v[208:211], v[64:67], v[92:95], v[208:211]
    ds_read_b64_tr_b16 v[106:107], v14 offset:8704
    v_mfma_f32_16x16x32_bf16 v[212:215], v[68:71], v[92:95], v[212:215]
    buffer_load_dwordx4 a[72:75], v20, s[20:23], s39 offen offset:3072 sc1
    ds_read_b64_tr_b16 v[108:109], v15 offset:8192
    v_mfma_f32_16x16x32_bf16 v[216:219], v[72:75], v[92:95], v[216:219]
    ds_read_b64_tr_b16 v[110:111], v15 offset:8704
    v_mfma_f32_16x16x32_bf16 v[220:223], v[76:79], v[92:95], v[220:223]
    ds_read_b64_tr_b16 v[112:113], v14 offset:12288
    v_mfma_f32_16x16x32_bf16 v[224:227], v[64:67], v[96:99], v[224:227]
    buffer_load_dwordx4 a[76:79], v21, s[20:23], s39 offen sc1
    ds_read_b64_tr_b16 v[114:115], v14 offset:12800
    v_mfma_f32_16x16x32_bf16 v[228:231], v[68:71], v[96:99], v[228:231]
    ds_read_b64_tr_b16 v[116:117], v15 offset:12288
    v_mfma_f32_16x16x32_bf16 v[232:235], v[72:75], v[96:99], v[232:235]
    ds_read_b64_tr_b16 v[118:119], v15 offset:12800
    s_add_u32 s39, s39, 5120
    s_sub_u32 s49, s39, 61440
    s_cmp_eq_u32 s39, s40
    s_cselect_b32 s39, s49, s39
    v_mfma_f32_16x16x32_bf16 v[236:239], v[76:79], v[96:99], v[236:239]
    buffer_load_dwordx4 a[80:83], v20, s[20:23], s39 offen sc1
    ds_read_b128 v[124:127], v11 offset:2048
    v_mfma_f32_16x16x32_bf16 v[240:243], v[64:67], v[100:103], v[240:243]
    ds_read_b128 v[128:131], v11 offset:4096
    v_mfma_f32_16x16x32_bf16 v[244:247], v[68:71], v[100:103], v[244:247]
    ds_read_b128 v[132:135], v11 offset:6144
    v_mfma_f32_16x16x32_bf16 v[248:251], v[72:75], v[100:103], v[248:251]
    ds_read_b128 v[136:139], v11 offset:8192
    v_mfma_f32_16x16x32_bf16 v[252:255], v[76:79], v[100:103], v[252:255]
    ds_read_b128 v[140:143], v11 offset:10240
    s_waitcnt lgkmcnt(11)
    v_mfma_f32_16x16x32_bf16 v[160:163], v[104:107], v[120:123], v[160:163]
    s_waitcnt lgkmcnt(9)
    v_mfma_f32_16x16x32_bf16 v[164:167], v[108:111], v[120:123], v[164:167]
    buffer_load_dwordx4 a[84:87], v20, s[20:23], s39 offen offset:1024 sc1
    s_waitcnt lgkmcnt(7)
    v_mfma_f32_16x16x32_bf16 v[168:171], v[112:115], v[120:123], v[168:171]
    s_waitcnt lgkmcnt(5)
    v_mfma_f32_16x16x32_bf16 v[172:175], v[116:119], v[120:123], v[172:175]
    s_waitcnt lgkmcnt(4)
    v_mfma_f32_16x16x32_bf16 v[176:179], v[104:107], v[124:127], v[176:179]
    buffer_load_dwordx4 a[88:91], v20, s[20:23], s39 offen offset:2048 sc1
    v_mfma_f32_16x16x32_bf16 v[180:183], v[108:111], v[124:127], v[180:183]
    v_mfma_f32_16x16x32_bf16 v[184:187], v[112:115], v[124:127], v[184:187]
    v_mfma_f32_16x16x32_bf16 v[188:191], v[116:119], v[124:127], v[188:191]
    buffer_load_dwordx4 a[92:95], v20, s[20:23], s39 offen offset:3072 sc1
    s_waitcnt lgkmcnt(3)
    v_mfma_f32_16x16x32_bf16 v[192:195], v[104:107], v[128:131], v[192:195]
    s_waitcnt lgkmcnt(0)
    v_mfma_f32_16x16x32_bf16 v[196:199], v[108:111], v[128:131], v[196:199]
    s_barrier
    v_mfma_f32_16x16x32_bf16 v[200:203], v[112:115], v[128:131], v[200:203]
    v_mfma_f32_16x16x32_bf16 v[204:207], v[116:119], v[128:131], v[204:207]
    v_mfma_f32_16x16x32_bf16 v[208:211], v[104:107], v[132:135], v[208:211]
    v_mfma_f32_16x16x32_bf16 v[212:215], v[108:111], v[132:135], v[212:215]
    buffer_load_dwordx4 a[96:99], v21, s[20:23], s39 offen sc1
    v_mfma_f32_16x16x32_bf16 v[216:219], v[112:115], v[132:135], v[216:219]
    v_mfma_f32_16x16x32_bf16 v[220:223], v[116:119], v[132:135], v[220:223]
    s_add_u32 s39, s39, 5120
    s_sub_u32 s49, s39, 61440
    s_cmp_eq_u32 s39, s40
    s_cselect_b32 s39, s49, s39
    v_mfma_f32_16x16x32_bf16 v[224:227], v[104:107], v[136:139], v[224:227]
    buffer_load_dwordx4 a[100:103], v20, s[20:23], s39 offen sc1
    v_mfma_f32_16x16x32_bf16 v[228:231], v[108:111], v[136:139], v[228:231]
    v_mfma_f32_16x16x32_bf16 v[232:235], v[112:115], v[136:139], v[232:235]
    v_mfma_f32_16x16x32_bf16 v[236:239], v[116:119], v[136:139], v[236:239]
    v_mfma_f32_16x16x32_bf16 v[240:243], v[104:107], v[140:143], v[240:243]
    v_mfma_f32_16x16x32_bf16 v[244:247], v[108:111], v[140:143], v[244:247]
    v_mfma_f32_16x16x32_bf16 v[248:251], v[112:115], v[140:143], v[248:251]
    v_mfma_f32_16x16x32_bf16 v[252:255], v[116:119], v[140:143], v[252:255]
L_join:
    s_nop 7
    v_pk_mul_f32 v[44:45], v[160:161], s[58:59]
    v_pk_mul_f32 v[46:47], v[162:163], s[58:59]
    v_pk_mul_f32 v[48:49], v[164:165], s[58:59]
    v_pk_mul_f32 v[50:51], v[166:167], s[58:59]
    v_exp_f32 v44, v44
    v_exp_f32 v45, v45
    v_exp_f32 v46, v46
    v_exp_f32 v47, v47
    v_exp_f32 v48, v48
    v_exp_f32 v49, v49
    v_exp_f32 v50, v50
    v_exp_f32 v51, v51
    v_pk_add_f32 v[44:45], v[44:45], 1.0 op_sel_hi:[1,0]
    v_pk_add_f32 v[46:47], v[46:47], 1.0 op_sel_hi:[1,0]
    v_pk_add_f32 v[48:49], v[48:49], 1.0 op_sel_hi:[1,0]
    v_pk_add_f32 v[50:51], v[50:51], 1.0 op_sel_hi:[1,0]
    v_rcp_f32 v44, v44
    buffer_load_dwordx4 a[104:107], v20, s[20:23], s39 offen offset:1024 sc1
    v_rcp_f32 v45, v45
    v_rcp_f32 v46, v46
    buffer_load_dwordx4 a[108:111], v20, s[20:23], s39 offen offset:2048 sc1
    v_rcp_f32 v47, v47
    v_rcp_f32 v48, v48
    buffer_load_dwordx4 a[112:115], v20, s[20:23], s39 offen offset:3072 sc1
    v_rcp_f32 v49, v49
    v_rcp_f32 v50, v50
    v_rcp_f32 v51, v51
    v_pk_mul_f32 v[52:53], v[176:177], s[58:59]
    v_pk_mul_f32 v[54:55], v[178:179], s[58:59]
    v_pk_mul_f32 v[56:57], v[180:181], s[58:59]
    v_pk_mul_f32 v[58:59], v[182:183], s[58:59]
    v_exp_f32 v52, v52
    v_pk_mul_f32 v[44:45], v[44:45], v[160:161]
    v_pk_mul_f32 v[46:47], v[46:47], v[162:163]
    v_exp_f32 v53, v53
    v_pk_mul_f32 v[48:49], v[48:49], v[164:165]
    v_pk_mul_f32 v[50:51], v[50:51], v[166:167]
    v_exp_f32 v54, v54
    v_pk_mul_f32 v[44:45], v[44:45], v[168:169]
    v_pk_mul_f32 v[46:47], v[46:47], v[170:171]
    v_exp_f32 v55, v55
    v_pk_mul_f32 v[48:49], v[48:49], v[172:173]
    v_pk_mul_f32 v[50:51], v[50:51], v[174:175]
    v_exp_f32 v56, v56
    v_cvt_pk_bf16_f32 v64, v44, v45
    v_cvt_pk_bf16_f32 v65, v46, v47
    v_exp_f32 v57, v57
    v_cvt_pk_bf16_f32 v66, v48, v49
    v_cvt_pk_bf16_f32 v67, v50, v51
    v_exp_f32 v58, v58
    v_exp_f32 v59, v59
    v_pk_add_f32 v[52:53], v[52:53], 1.0 op_sel_hi:[1,0]
    v_pk_add_f32 v[54:55], v[54:55], 1.0 op_sel_hi:[1,0]
    v_pk_add_f32 v[56:57], v[56:57], 1.0 op_sel_hi:[1,0]
    v_pk_add_f32 v[58:59], v[58:59], 1.0 op_sel_hi:[1,0]
    v_rcp_f32 v52, v52
    buffer_load_dwordx4 a[116:119], v21, s[20:23], s39 offen sc1
    v_rcp_f32 v53, v53
    v_rcp_f32 v54, v54
    s_add_u32 s39, s39, 5120
    s_sub_u32 s49, s39, 61440
    s_cmp_eq_u32 s39, s40
    s_cselect_b32 s39, s49, s39
    buffer_load_dwordx4 a[120:123], v20, s[20:23], s39 offen sc1
    v_rcp_f32 v55, v55
    v_rcp_f32 v56, v56
    buffer_load_dwordx4 a[124:127], v20, s[20:23], s39 offen offset:1024 sc1
    v_rcp_f32 v57, v57
    v_rcp_f32 v58, v58
    v_rcp_f32 v59, v59
    v_pk_mul_f32 v[44:45], v[192:193], s[58:59]
    v_pk_mul_f32 v[46:47], v[194:195], s[58:59]
    v_pk_mul_f32 v[48:49], v[196:197], s[58:59]
    v_pk_mul_f32 v[50:51], v[198:199], s[58:59]
    v_exp_f32 v44, v44
    v_pk_mul_f32 v[52:53], v[52:53], v[176:177]
    v_pk_mul_f32 v[54:55], v[54:55], v[178:179]
    v_exp_f32 v45, v45
    v_pk_mul_f32 v[56:57], v[56:57], v[180:181]
    v_pk_mul_f32 v[58:59], v[58:59], v[182:183]
    v_exp_f32 v46, v46
    v_pk_mul_f32 v[52:53], v[52:53], v[184:185]
    v_pk_mul_f32 v[54:55], v[54:55], v[186:187]
    v_exp_f32 v47, v47
    v_pk_mul_f32 v[56:57], v[56:57], v[188:189]
    v_pk_mul_f32 v[58:59], v[58:59], v[190:191]
    v_exp_f32 v48, v48
    v_cvt_pk_bf16_f32 v68, v52, v53
    v_cvt_pk_bf16_f32 v69, v54, v55
    v_exp_f32 v49, v49
    v_cvt_pk_bf16_f32 v70, v56, v57
    v_cvt_pk_bf16_f32 v71, v58, v59
    v_exp_f32 v50, v50
    v_exp_f32 v51, v51
    v_pk_add_f32 v[44:45], v[44:45], 1.0 op_sel_hi:[1,0]
    v_pk_add_f32 v[46:47], v[46:47], 1.0 op_sel_hi:[1,0]
    v_pk_add_f32 v[48:49], v[48:49], 1.0 op_sel_hi:[1,0]
    v_pk_add_f32 v[50:51], v[50:51], 1.0 op_sel_hi:[1,0]
    v_rcp_f32 v44, v44
    buffer_load_dwordx4 a[128:131], v20, s[20:23], s39 offen offset:2048 sc1
    v_rcp_f32 v45, v45
    v_rcp_f32 v46, v46
    buffer_load_dwordx4 a[132:135], v20, s[20:23], s39 offen offset:3072 sc1
    v_rcp_f32 v47, v47
    v_rcp_f32 v48, v48
    buffer_load_dwordx4 a[136:139], v21, s[20:23], s39 offen sc1
    v_rcp_f32 v49, v49
    v_rcp_f32 v50, v50
    v_rcp_f32 v51, v51
    v_pk_mul_f32 v[52:53], v[208:209], s[58:59]
    v_pk_mul_f32 v[54:55], v[210:211], s[58:59]
    v_pk_mul_f32 v[56:57], v[212:213], s[58:59]
    v_pk_mul_f32 v[58:59], v[214:215], s[58:59]
    v_exp_f32 v52, v52
    v_pk_mul_f32 v[44:45], v[44:45], v[192:193]
    v_pk_mul_f32 v[46:47], v[46:47], v[194:195]
    v_exp_f32 v53, v53
    v_pk_mul_f32 v[48:49], v[48:49], v[196:197]
    v_pk_mul_f32 v[50:51], v[50:51], v[198:199]
    v_exp_f32 v54, v54
    v_pk_mul_f32 v[44:45], v[44:45], v[200:201]
    v_pk_mul_f32 v[46:47], v[46:47], v[202:203]
    v_exp_f32 v55, v55
    v_pk_mul_f32 v[48:49], v[48:49], v[204:205]
    v_pk_mul_f32 v[50:51], v[50:51], v[206:207]
    v_exp_f32 v56, v56
    v_cvt_pk_bf16_f32 v72, v44, v45
    v_cvt_pk_bf16_f32 v73, v46, v47
    v_exp_f32 v57, v57
    v_cvt_pk_bf16_f32 v74, v48, v49
    v_cvt_pk_bf16_f32 v75, v50, v51
    v_exp_f32 v58, v58
    v_exp_f32 v59, v59
    v_pk_add_f32 v[52:53], v[52:53], 1.0 op_sel_hi:[1,0]
    v_pk_add_f32 v[54:55], v[54:55], 1.0 op_sel_hi:[1,0]
    v_pk_add_f32 v[56:57], v[56:57], 1.0 op_sel_hi:[1,0]
    v_pk_add_f32 v[58:59], v[58:59], 1.0 op_sel_hi:[1,0]
    v_rcp_f32 v52, v52
    s_add_u32 s39, s39, 5120
    s_sub_u32 s49, s39, 61440
    s_cmp_eq_u32 s39, s40
    s_cselect_b32 s39, s49, s39
    buffer_load_dwordx4 a[140:143], v20, s[20:23], s39 offen sc1
    v_rcp_f32 v53, v53
    v_rcp_f32 v54, v54
    buffer_load_dwordx4 a[144:147], v20, s[20:23], s39 offen offset:1024 sc1
    v_rcp_f32 v55, v55
    v_rcp_f32 v56, v56
    buffer_load_dwordx4 a[148:151], v20, s[20:23], s39 offen offset:2048 sc1
    v_rcp_f32 v57, v57
    v_rcp_f32 v58, v58
    v_rcp_f32 v59, v59
    v_pk_mul_f32 v[44:45], v[224:225], s[58:59]
    v_pk_mul_f32 v[46:47], v[226:227], s[58:59]
    v_pk_mul_f32 v[48:49], v[228:229], s[58:59]
    v_pk_mul_f32 v[50:51], v[230:231], s[58:59]
    v_exp_f32 v44, v44
    v_pk_mul_f32 v[52:53], v[52:53], v[208:209]
    v_pk_mul_f32 v[54:55], v[54:55], v[210:211]
    v_exp_f32 v45, v45
    v_pk_mul_f32 v[56:57], v[56:57], v[212:213]
    v_pk_mul_f32 v[58:59], v[58:59], v[214:215]
    v_exp_f32 v46, v46
    v_pk_mul_f32 v[52:53], v[52:53], v[216:217]
    v_pk_mul_f32 v[54:55], v[54:55], v[218:219]
    v_exp_f32 v47, v47
    v_pk_mul_f32 v[56:57], v[56:57], v[220:221]
    v_pk_mul_f32 v[58:59], v[58:59], v[222:223]
    v_exp_f32 v48, v48
    v_cvt_pk_bf16_f32 v76, v52, v53
    v_cvt_pk_bf16_f32 v77, v54, v55
    v_exp_f32 v49, v49
    v_cvt_pk_bf16_f32 v78, v56, v57
    v_cvt_pk_bf16_f32 v79, v58, v59
    v_exp_f32 v50, v50
    v_exp_f32 v51, v51
    v_pk_add_f32 v[44:45], v[44:45], 1.0 op_sel_hi:[1,0]
    v_pk_add_f32 v[46:47], v[46:47], 1.0 op_sel_hi:[1,0]
    v_pk_add_f32 v[48:49], v[48:49], 1.0 op_sel_hi:[1,0]
    v_pk_add_f32 v[50:51], v[50:51], 1.0 op_sel_hi:[1,0]
    v_rcp_f32 v44, v44
    buffer_load_dwordx4 a[152:155], v20, s[20:23], s39 offen offset:3072 sc1
    v_rcp_f32 v45, v45
    v_rcp_f32 v46, v46
    buffer_load_dwordx4 a[156:159], v21, s[20:23], s39 offen sc1
    v_rcp_f32 v47, v47
    v_rcp_f32 v48, v48
    v_rcp_f32 v49, v49
    v_rcp_f32 v50, v50
    v_rcp_f32 v51, v51
    v_pk_mul_f32 v[52:53], v[240:241], s[58:59]
    v_pk_mul_f32 v[54:55], v[242:243], s[58:59]
    v_pk_mul_f32 v[56:57], v[244:245], s[58:59]
    v_pk_mul_f32 v[58:59], v[246:247], s[58:59]
    v_exp_f32 v52, v52
    v_pk_mul_f32 v[44:45], v[44:45], v[224:225]
    v_pk_mul_f32 v[46:47], v[46:47], v[226:227]
    v_exp_f32 v53, v53
    v_pk_mul_f32 v[48:49], v[48:49], v[228:229]
    v_pk_mul_f32 v[50:51], v[50:51], v[230:231]
    v_exp_f32 v54, v54
    v_pk_mul_f32 v[44:45], v[44:45], v[232:233]
    v_pk_mul_f32 v[46:47], v[46:47], v[234:235]
    v_exp_f32 v55, v55
    v_pk_mul_f32 v[48:49], v[48:49], v[236:237]
    v_pk_mul_f32 v[50:51], v[50:51], v[238:239]
    v_exp_f32 v56, v56
    v_cvt_pk_bf16_f32 v80, v44, v45
    v_cvt_pk_bf16_f32 v81, v46, v47
    v_exp_f32 v57, v57
    v_cvt_pk_bf16_f32 v82, v48, v49
    v_cvt_pk_bf16_f32 v83, v50, v51
    v_exp_f32 v58, v58
    v_exp_f32 v59, v59
    v_pk_add_f32 v[52:53], v[52:53], 1.0 op_sel_hi:[1,0]
    v_pk_add_f32 v[54:55], v[54:55], 1.0 op_sel_hi:[1,0]
    v_pk_add_f32 v[56:57], v[56:57], 1.0 op_sel_hi:[1,0]
    v_pk_add_f32 v[58:59], v[58:59], 1.0 op_sel_hi:[1,0]
    v_rcp_f32 v52, v52
    v_rcp_f32 v53, v53
    v_rcp_f32 v54, v54
    v_rcp_f32 v55, v55
    v_rcp_f32 v56, v56
    v_rcp_f32 v57, v57
    v_rcp_f32 v58, v58
    v_rcp_f32 v59, v59
    v_pk_mul_f32 v[52:53], v[52:53], v[240:241]
    v_pk_mul_f32 v[54:55], v[54:55], v[242:243]
    v_pk_mul_f32 v[56:57], v[56:57], v[244:245]
    v_pk_mul_f32 v[58:59], v[58:59], v[246:247]
    v_pk_mul_f32 v[52:53], v[52:53], v[248:249]
    v_pk_mul_f32 v[54:55], v[54:55], v[250:251]
    v_pk_mul_f32 v[56:57], v[56:57], v[252:253]
    v_pk_mul_f32 v[58:59], v[58:59], v[254:255]
    v_cvt_pk_bf16_f32 v84, v52, v53
    v_cvt_pk_bf16_f32 v85, v54, v55
    v_cvt_pk_bf16_f32 v86, v56, v57
    v_cvt_pk_bf16_f32 v87, v58, v59
    s_cmp_lt_u32 s2, 240
    s_cbranch_scc1 L_noswap
    s_nop 0
    v_permlane16_swap_b32 v80, v82
    v_permlane16_swap_b32 v81, v83
    v_permlane16_swap_b32 v84, v86
    v_permlane16_swap_b32 v85, v87
L_noswap:
    buffer_store_dwordx4 v[64:67], v17, s[20:23], s41 offen sc1
    buffer_store_dwordx4 v[68:71], v17, s[20:23], s42 offen sc1
    buffer_store_dwordx4 v[72:75], v17, s[20:23], s43 offen sc1
    buffer_store_dwordx4 v[76:79], v17, s[20:23], s44 offen sc1
    buffer_store_dwordx4 v[80:83], v156, s[20:23], s45 offen sc1
    buffer_store_dwordx4 v[84:87], v156, s[20:23], s46 offen sc1
    s_mov_b32 s60, s70
    s_add_u32 s51, s33, 49152
    s_add_u32 s61, s60, 4096
    s_cmp_eq_u32 s61, s51
    s_cselect_b32 s61, s33, s61
    s_add_u32 s62, s61, 4096
    s_cmp_eq_u32 s62, s51
    s_cselect_b32 s62, s33, s62
    s_add_u32 s63, s62, 4096
    s_cmp_eq_u32 s63, s51
    s_cselect_b32 s63, s33, s63
    s_add_u32 s64, s63, 4096
    s_cmp_eq_u32 s64, s51
    s_cselect_b32 s64, s33, s64
    s_add_u32 s65, s64, 4096
    s_cmp_eq_u32 s65, s51
    s_cselect_b32 s65, s33, s65
    s_add_u32 s66, s65, 4096
    s_cmp_eq_u32 s66, s51
    s_cselect_b32 s66, s33, s66
    s_add_u32 s67, s66, 4096
    s_cmp_eq_u32 s67, s51
    s_cselect_b32 s67, s33, s67
    s_add_u32 s68, s67, 4096
    s_cmp_eq_u32 s68, s51
    s_cselect_b32 s68, s33, s68
    s_add_u32 s69, s68, 4096
    s_cmp_eq_u32 s69, s51
    s_cselect_b32 s69, s33, s69
    s_add_u32 s70, s69, 4096
    s_cmp_eq_u32 s70, s51
    s_cselect_b32 s70, s33, s70
    s_add_u32 s71, s70, 4096
    s_cmp_eq_u32 s71, s51
    s_cselect_b32 s71, s33, s71
    s_waitcnt vmcnt(0)
    s_barrier
    s_mov_b64 exec, 0xff
    buffer_store_dwordx4 v[40:43], v20, s[20:23], s7 offen sc1
    s_mov_b64 exec, -1
L_published:
    s_add_u32 s39, s39, 5120
    s_sub_u32 s49, s39, 61440
    s_cmp_eq_u32 s39, s40
    s_cselect_b32 s39, s49, s39
    buffer_load_dwordx4 a[160:163], v20, s[20:23], s39 offen sc1
    buffer_load_dwordx4 a[164:167], v20, s[20:23], s39 offen offset:1024 sc1
    buffer_load_dwordx4 a[168:171], v20, s[20:23], s39 offen offset:2048 sc1
    buffer_load_dwordx4 a[172:175], v20, s[20:23], s39 offen offset:3072 sc1
    buffer_load_dwordx4 a[176:179], v21, s[20:23], s39 offen sc1
    s_add_u32 s39, s39, 5120
    s_sub_u32 s49, s39, 61440
    s_cmp_eq_u32 s39, s40
    s_cselect_b32 s39, s49, s39
    buffer_load_dwordx4 a[180:183], v20, s[20:23], s39 offen sc1
    buffer_load_dwordx4 a[184:187], v20, s[20:23], s39 offen offset:1024 sc1
    buffer_load_dwordx4 a[188:191], v20, s[20:23], s39 offen offset:2048 sc1
    buffer_load_dwordx4 a[192:195], v20, s[20:23], s39 offen offset:3072 sc1
    buffer_load_dwordx4 a[196:199], v21, s[20:23], s39 offen sc1
    s_add_u32 s39, s39, 5120
    s_sub_u32 s49, s39, 61440
    s_cmp_eq_u32 s39, s40
    s_cselect_b32 s39, s49, s39
    buffer_load_dwordx4 a[200:203], v20, s[20:23], s39 offen sc1
    buffer_load_dwordx4 a[204:207], v20, s[20:23], s39 offen offset:1024 sc1
    buffer_load_dwordx4 a[208:211], v20, s[20:23], s39 offen offset:2048 sc1
    buffer_load_dwordx4 a[212:215], v20, s[20:23], s39 offen offset:3072 sc1
    buffer_load_dwordx4 a[216:219], v21, s[20:23], s39 offen sc1
    s_add_u32 s39, s39, 5120
    s_sub_u32 s49, s39, 61440
    s_cmp_eq_u32 s39, s40
    s_cselect_b32 s39, s49, s39
    buffer_load_dwordx4 a[220:223], v20, s[20:23], s39 offen sc1
    buffer_load_dwordx4 a[224:227], v20, s[20:23], s39 offen offset:1024 sc1
    buffer_load_dwordx4 a[228:231], v20, s[20:23], s39 offen offset:2048 sc1
    buffer_load_dwordx4 a[232:235], v20, s[20:23], s39 offen offset:3072 sc1
    buffer_load_dwordx4 a[236:239], v21, s[20:23], s39 offen sc1
    s_mov_b32 s5, 60000
L_poll_spin:
    buffer_load_dwordx2 v[152:153], v36, s[20:23], 0 offen sc1
    s_waitcnt vmcnt(0)
    v_cmp_ne_u64 vcc, v[152:153], v[40:41]
    s_nop 1
    s_cbranch_vccz L_poll_ok
    s_sub_u32 s5, s5, 1
    s_cmp_lg_u32 s5, 0
    s_cbranch_scc1 L_poll_spin
L_poll_ok:
    buffer_load_dwordx4 v[64:67], v22, s[20:23], s60 offen sc1
    buffer_load_dwordx4 v[68:71], v22, s[20:23], s61 offen sc1
    buffer_load_dwordx4 v[72:75], v22, s[20:23], s62 offen sc1
    buffer_load_dwordx4 v[76:79], v22, s[20:23], s63 offen sc1
    buffer_load_dwordx4 v[80:83], v22, s[20:23], s64 offen sc1
    buffer_load_dwordx4 v[84:87], v22, s[20:23], s65 offen sc1
    buffer_load_dwordx4 v[88:91], v22, s[20:23], s66 offen sc1
    buffer_load_dwordx4 v[92:95], v22, s[20:23], s67 offen sc1
    buffer_load_dwordx4 v[96:99], v22, s[20:23], s68 offen sc1
    s_waitcnt vmcnt(8)
    v_mfma_f32_16x16x32_bf16 v[112:115], a[0:3], v[64:67], 0
    buffer_load_dwordx4 v[100:103], v22, s[20:23], s69 offen sc1
    v_mfma_f32_16x16x32_bf16 v[116:119], a[4:7], v[64:67], 0
    v_mfma_f32_16x16x32_bf16 v[120:123], a[8:11], v[64:67], 0
    v_mfma_f32_16x16x32_bf16 v[124:127], a[12:15], v[64:67], 0
    v_mfma_f32_16x16x32_bf16 v[128:131], a[16:19], v[64:67], 0
    s_waitcnt vmcnt(8)
    v_mfma_f32_16x16x32_bf16 v[112:115], a[20:23], v[68:71], v[112:115]
    buffer_load_dwordx4 v[64:67], v22, s[20:23], s70 offen sc1
    v_mfma_f32_16x16x32_bf16 v[116:119], a[24:27], v[68:71], v[116:119]
    v_mfma_f32_16x16x32_bf16 v[120:123], a[28:31], v[68:71], v[120:123]
    v_mfma_f32_16x16x32_bf16 v[124:127], a[32:35], v[68:71], v[124:127]
    v_mfma_f32_16x16x32_bf16 v[128:131], a[36:39], v[68:71], v[128:131]
    s_waitcnt vmcnt(8)
    v_mfma_f32_16x16x32_bf16 v[112:115], a[40:43], v[72:75], v[112:115]
    buffer_load_dwordx4 v[68:71], v22, s[20:23], s71 offen sc1
    v_mfma_f32_16x16x32_bf16 v[116:119], a[44:47], v[72:75], v[116:119]
    v_mfma_f32_16x16x32_bf16 v[120:123], a[48:51], v[72:75], v[120:123]
    v_mfma_f32_16x16x32_bf16 v[124:127], a[52:55], v[72:75], v[124:127]
    v_mfma_f32_16x16x32_bf16 v[128:131], a[56:59], v[72:75], v[128:131]
    s_waitcnt vmcnt(8)
    v_mfma_f32_16x16x32_bf16 v[112:115], a[60:63], v[76:79], v[112:115]
    buffer_load_dwordx4 v[72:75], v23, s[20:23], s60 offen sc1
    v_mfma_f32_16x16x32_bf16 v[116:119], a[64:67], v[76:79], v[116:119]
    v_mfma_f32_16x16x32_bf16 v[120:123], a[68:71], v[76:79], v[120:123]
    v_mfma_f32_16x16x32_bf16 v[124:127], a[72:75], v[76:79], v[124:127]
    v_mfma_f32_16x16x32_bf16 v[128:131], a[76:79], v[76:79], v[128:131]
    s_waitcnt vmcnt(8)
    v_mfma_f32_16x16x32_bf16 v[112:115], a[80:83], v[80:83], v[112:115]
    buffer_load_dwordx4 v[76:79], v23, s[20:23], s61 offen sc1
    v_mfma_f32_16x16x32_bf16 v[116:119], a[84:87], v[80:83], v[116:119]
    v_mfma_f32_16x16x32_bf16 v[120:123], a[88:91], v[80:83], v[120:123]
    v_mfma_f32_16x16x32_bf16 v[124:127], a[92:95], v[80:83], v[124:127]
    v_mfma_f32_16x16x32_bf16 v[128:131], a[96:99], v[80:83], v[128:131]
    s_waitcnt vmcnt(8)
    v_mfma_f32_16x16x32_bf16 v[112:115], a[100:103], v[84:87], v[112:115]
    buffer_load_dwordx4 v[80:83], v23, s[20:23], s62 offen sc1
    v_mfma_f32_16x16x32_bf16 v[116:119], a[104:107], v[84:87], v[116:119]
    v_mfma_f32_16x16x32_bf16 v[120:123], a[108:111], v[84:87], v[120:123]
    v_mfma_f32_16x16x32_bf16 v[124:127], a[112:115], v[84:87], v[124:127]
    v_mfma_f32_16x16x32_bf16 v[128:131], a[116:119], v[84:87], v[128:131]
    s_waitcnt vmcnt(8)
    v_mfma_f32_16x16x32_bf16 v[112:115], a[120:123], v[88:91], v[112:115]
    buffer_load_dwordx4 v[84:87], v23, s[20:23], s63 offen sc1
    v_mfma_f32_16x16x32_bf16 v[116:119], a[124:127], v[88:91], v[116:119]
    v_mfma_f32_16x16x32_bf16 v[120:123], a[128:131], v[88:91], v[120:123]
    v_mfma_f32_16x16x32_bf16 v[124:127], a[132:135], v[88:91], v[124:127]
    v_mfma_f32_16x16x32_bf16 v[128:131], a[136:139], v[88:91], v[128:131]
    s_waitcnt vmcnt(8)
    v_mfma_f32_16x16x32_bf16 v[112:115], a[140:143], v[92:95], v[112:115]
    buffer_load_dwordx4 v[88:91], v23, s[20:23], s64 offen sc1
    v_mfma_f32_16x16x32_bf16 v[116:119], a[144:147], v[92:95], v[116:119]
    v_mfma_f32_16x16x32_bf16 v[120:123], a[148:151], v[92:95], v[120:123]
    v_mfma_f32_16x16x32_bf16 v[124:127], a[152:155], v[92:95], v[124:127]
    v_mfma_f32_16x16x32_bf16 v[128:131], a[156:159], v[92:95], v[128:131]
    s_waitcnt vmcnt(8)
    v_mfma_f32_16x16x32_bf16 v[112:115], a[160:163], v[96:99], v[112:115]
    buffer_load_dwordx4 v[92:95], v23, s[20:23], s65 offen sc1
    v_mfma_f32_16x16x32_bf16 v[116:119], a[164:167], v[96:99], v[116:119]
    v_mfma_f32_16x16x32_bf16 v[120:123], a[168:171], v[96:99], v[120:123]
    v_mfma_f32_16x16x32_bf16 v[124:127], a[172:175], v[96:99], v[124:127]
    v_mfma_f32_16x16x32_bf16 v[128:131], a[176:179], v[96:99], v[128:131]
    s_waitcnt vmcnt(8)
    v_mfma_f32_16x16x32_bf16 v[112:115], a[180:183], v[100:103], v[112:115]
    buffer_load_dwordx4 v[96:99], v23, s[20:23], s66 offen sc1
    v_mfma_f32_16x16x32_bf16 v[116:119], a[184:187], v[100:103], v[116:119]
    v_mfma_f32_16x16x32_bf16 v[120:123], a[188:191], v[100:103], v[120:123]
    v_mfma_f32_16x16x32_bf16 v[124:127], a[192:195], v[100:103], v[124:127]
    v_mfma_f32_16x16x32_bf16 v[128:131], a[196:199], v[100:103], v[128:131]
    s_waitcnt vmcnt(8)
    v_mfma_f32_16x16x32_bf16 v[112:115], a[200:203], v[64:67], v[112:115]
    buffer_load_dwordx4 v[100:103], v23, s[20:23], s67 offen sc1
    v_mfma_f32_16x16x32_bf16 v[116:119], a[204:207], v[64:67], v[116:119]
    v_mfma_f32_16x16x32_bf16 v[120:123], a[208:211], v[64:67], v[120:123]
    v_mfma_f32_16x16x32_bf16 v[124:127], a[212:215], v[64:67], v[124:127]
    v_mfma_f32_16x16x32_bf16 v[128:131], a[216:219], v[64:67], v[128:131]
    s_waitcnt vmcnt(8)
    v_mfma_f32_16x16x32_bf16 v[112:115], a[220:223], v[68:71], v[112:115]
    buffer_load_dwordx4 v[64:67], v23, s[20:23], s68 offen sc1
    v_mfma_f32_16x16x32_bf16 v[116:119], a[224:227], v[68:71], v[116:119]
    v_mfma_f32_16x16x32_bf16 v[120:123], a[228:231], v[68:71], v[120:123]
    v_mfma_f32_16x16x32_bf16 v[124:127], a[232:235], v[68:71], v[124:127]
    v_mfma_f32_16x16x32_bf16 v[128:131], a[236:239], v[68:71], v[128:131]
    s_waitcnt vmcnt(8)
    v_mfma_f32_16x16x32_bf16 v[132:135], a[0:3], v[72:75], 0
    buffer_load_dwordx4 v[68:71], v23, s[20:23], s69 offen sc1
    v_mfma_f32_16x16x32_bf16 v[136:139], a[4:7], v[72:75], 0
    v_mfma_f32_16x16x32_bf16 v[140:143], a[8:11], v[72:75], 0
    v_mfma_f32_16x16x32_bf16 v[144:147], a[12:15], v[72:75], 0
    v_mfma_f32_16x16x32_bf16 v[148:151], a[16:19], v[72:75], 0
    s_waitcnt vmcnt(8)
    v_mfma_f32_16x16x32_bf16 v[132:135], a[20:23], v[76:79], v[132:135]
    buffer_load_dwordx4 v[72:75], v23, s[20:23], s70 offen sc1
    v_mfma_f32_16x16x32_bf16 v[136:139], a[24:27], v[76:79], v[136:139]
    v_mfma_f32_16x16x32_bf16 v[140:143], a[28:31], v[76:79], v[140:143]
    ds_write_b128 v26, v[112:115] offset:0
    v_mfma_f32_16x16x32_bf16 v[144:147], a[32:35], v[76:79], v[144:147]
    v_mfma_f32_16x16x32_bf16 v[148:151], a[36:39], v[76:79], v[148:151]
    s_waitcnt vmcnt(8)
    v_mfma_f32_16x16x32_bf16 v[132:135], a[40:43], v[80:83], v[132:135]
    buffer_load_dwordx4 v[76:79], v23, s[20:23], s71 offen sc1
    v_mfma_f32_16x16x32_bf16 v[136:139], a[44:47], v[80:83], v[136:139]
    v_mfma_f32_16x16x32_bf16 v[140:143], a[48:51], v[80:83], v[140:143]
    ds_write_b128 v26, v[116:119] offset:1024
    v_mfma_f32_16x16x32_bf16 v[144:147], a[52:55], v[80:83], v[144:147]
    v_mfma_f32_16x16x32_bf16 v[148:151], a[56:59], v[80:83], v[148:151]
    s_waitcnt vmcnt(8)
    v_mfma_f32_16x16x32_bf16 v[132:135], a[60:63], v[84:87], v[132:135]
    buffer_load_dwordx4 v[80:83], v24, s[20:23], s60 offen sc1
    v_mfma_f32_16x16x32_bf16 v[136:139], a[64:67], v[84:87], v[136:139]
    v_mfma_f32_16x16x32_bf16 v[140:143], a[68:71], v[84:87], v[140:143]
    ds_write_b128 v26, v[120:123] offset:2048
    v_mfma_f32_16x16x32_bf16 v[144:147], a[72:75], v[84:87], v[144:147]
    v_mfma_f32_16x16x32_bf16 v[148:151], a[76:79], v[84:87], v[148:151]
    s_waitcnt vmcnt(8)
    v_mfma_f32_16x16x32_bf16 v[132:135], a[80:83], v[88:91], v[132:135]
    buffer_load_dwordx4 v[84:87], v24, s[20:23], s61 offen sc1
    v_mfma_f32_16x16x32_bf16 v[136:139], a[84:87], v[88:91], v[136:139]
    v_mfma_f32_16x16x32_bf16 v[140:143], a[88:91], v[88:91], v[140:143]
    ds_write_b128 v26, v[124:127] offset:3072
    v_mfma_f32_16x16x32_bf16 v[144:147], a[92:95], v[88:91], v[144:147]
    v_mfma_f32_16x16x32_bf16 v[148:151], a[96:99], v[88:91], v[148:151]
    s_waitcnt vmcnt(8)
    v_mfma_f32_16x16x32_bf16 v[132:135], a[100:103], v[92:95], v[132:135]
    buffer_load_dwordx4 v[88:91], v24, s[20:23], s62 offen sc1
    v_mfma_f32_16x16x32_bf16 v[136:139], a[104:107], v[92:95], v[136:139]
    v_mfma_f32_16x16x32_bf16 v[140:143], a[108:111], v[92:95], v[140:143]
    ds_write_b128 v26, v[128:131] offset:4096
    v_mfma_f32_16x16x32_bf16 v[144:147], a[112:115], v[92:95], v[144:147]
    v_mfma_f32_16x16x32_bf16 v[148:151], a[116:119], v[92:95], v[148:151]
    s_waitcnt vmcnt(8)
    v_mfma_f32_16x16x32_bf16 v[132:135], a[120:123], v[96:99], v[132:135]
    buffer_load_dwordx4 v[92:95], v24, s[20:23], s63 offen sc1
    v_mfma_f32_16x16x32_bf16 v[136:139], a[124:127], v[96:99], v[136:139]
    v_mfma_f32_16x16x32_bf16 v[140:143], a[128:131], v[96:99], v[140:143]
    v_mfma_f32_16x16x32_bf16 v[144:147], a[132:135], v[96:99], v[144:147]
    v_mfma_f32_16x16x32_bf16 v[148:151], a[136:139], v[96:99], v[148:151]
    s_waitcnt vmcnt(8)
    v_mfma_f32_16x16x32_bf16 v[132:135], a[140:143], v[100:103], v[132:135]
    buffer_load_dwordx4 v[96:99], v24, s[20:23], s64 offen sc1
    s_waitcnt lgkmcnt(0)
    s_barrier
    v_mfma_f32_16x16x32_bf16 v[136:139], a[144:147], v[100:103], v[136:139]
    ds_read_b128 v[112:115], v27 offset:0
    v_mfma_f32_16x16x32_bf16 v[140:143], a[148:151], v[100:103], v[140:143]
    v_mfma_f32_16x16x32_bf16 v[144:147], a[152:155], v[100:103], v[144:147]
    ds_read_b128 v[116:119], v27 offset:1024
    v_mfma_f32_16x16x32_bf16 v[148:151], a[156:159], v[100:103], v[148:151]
    s_waitcnt vmcnt(8)
    v_mfma_f32_16x16x32_bf16 v[132:135], a[160:163], v[64:67], v[132:135]
    buffer_load_dwordx4 v[100:103], v24, s[20:23], s65 offen sc1
    v_mfma_f32_16x16x32_bf16 v[136:139], a[164:167], v[64:67], v[136:139]
    ds_read_b128 v[120:123], v27 offset:2048
    v_mfma_f32_16x16x32_bf16 v[140:143], a[168:171], v[64:67], v[140:143]
    v_mfma_f32_16x16x32_bf16 v[144:147], a[172:175], v[64:67], v[144:147]
    ds_read_b128 v[124:127], v27 offset:3072
    v_mfma_f32_16x16x32_bf16 v[148:151], a[176:179], v[64:67], v[148:151]
    s_waitcnt vmcnt(8)
    v_mfma_f32_16x16x32_bf16 v[132:135], a[180:183], v[68:71], v[132:135]
    buffer_load_dwordx4 v[64:67], v24, s[20:23], s66 offen sc1
    v_mfma_f32_16x16x32_bf16 v[136:139], a[184:187], v[68:71], v[136:139]
    ds_read_b128 v[128:131], v27 offset:4096
    v_mfma_f32_16x16x32_bf16 v[140:143], a[188:191], v[68:71], v[140:143]
    v_mfma_f32_16x16x32_bf16 v[144:147], a[192:195], v[68:71], v[144:147]
    v_mfma_f32_16x16x32_bf16 v[148:151], a[196:199], v[68:71], v[148:151]
    s_waitcnt vmcnt(8)
    v_mfma_f32_16x16x32_bf16 v[132:135], a[200:203], v[72:75], v[132:135]
    buffer_load_dwordx4 v[68:71], v24, s[20:23], s67 offen sc1
    v_mfma_f32_16x16x32_bf16 v[136:139], a[204:207], v[72:75], v[136:139]
    v_mfma_f32_16x16x32_bf16 v[140:143], a[208:211], v[72:75], v[140:143]
    v_mfma_f32_16x16x32_bf16 v[144:147], a[212:215], v[72:75], v[144:147]
    v_mfma_f32_16x16x32_bf16 v[148:151], a[216:219], v[72:75], v[148:151]
    s_waitcnt vmcnt(8)
    v_mfma_f32_16x16x32_bf16 v[132:135], a[220:223], v[76:79], v[132:135]
    buffer_load_dwordx4 v[72:75], v24, s[20:23], s68 offen sc1
    v_mfma_f32_16x16x32_bf16 v[136:139], a[224:227], v[76:79], v[136:139]
    v_mfma_f32_16x16x32_bf16 v[140:143], a[228:231], v[76:79], v[140:143]
    v_mfma_f32_16x16x32_bf16 v[144:147], a[232:235], v[76:79], v[144:147]
    v_mfma_f32_16x16x32_bf16 v[148:151], a[236:239], v[76:79], v[148:151]
    s_waitcnt vmcnt(8)
    s_waitcnt lgkmcnt(4)
    v_mfma_f32_16x16x32_bf16 v[112:115], a[0:3], v[80:83], v[112:115]
    buffer_load_dwordx4 v[76:79], v24, s[20:23], s69 offen sc1
    s_waitcnt lgkmcnt(3)
    v_mfma_f32_16x16x32_bf16 v[116:119], a[4:7], v[80:83], v[116:119]
    s_waitcnt lgkmcnt(2)
    v_mfma_f32_16x16x32_bf16 v[120:123], a[8:11], v[80:83], v[120:123]
    s_waitcnt lgkmcnt(1)
    v_mfma_f32_16x16x32_bf16 v[124:127], a[12:15], v[80:83], v[124:127]
    s_waitcnt lgkmcnt(0)
    v_mfma_f32_16x16x32_bf16 v[128:131], a[16:19], v[80:83], v[128:131]
    s_waitcnt vmcnt(8)
    v_mfma_f32_16x16x32_bf16 v[112:115], a[20:23], v[84:87], v[112:115]
    buffer_load_dwordx4 v[80:83], v24, s[20:23], s70 offen sc1
    v_mfma_f32_16x16x32_bf16 v[116:119], a[24:27], v[84:87], v[116:119]
    v_mfma_f32_16x16x32_bf16 v[120:123], a[28:31], v[84:87], v[120:123]
    ds_write_b128 v26, v[132:135] offset:20480
    v_mfma_f32_16x16x32_bf16 v[124:127], a[32:35], v[84:87], v[124:127]
    v_mfma_f32_16x16x32_bf16 v[128:131], a[36:39], v[84:87], v[128:131]
    s_waitcnt vmcnt(8)
    v_mfma_f32_16x16x32_bf16 v[112:115], a[40:43], v[88:91], v[112:115]
    buffer_load_dwordx4 v[84:87], v24, s[20:23], s71 offen sc1
    v_mfma_f32_16x16x32_bf16 v[116:119], a[44:47], v[88:91], v[116:119]
    v_mfma_f32_16x16x32_bf16 v[120:123], a[48:51], v[88:91], v[120:123]
    ds_write_b128 v26, v[136:139] offset:21504
    v_mfma_f32_16x16x32_bf16 v[124:127], a[52:55], v[88:91], v[124:127]
    v_mfma_f32_16x16x32_bf16 v[128:131], a[56:59], v[88:91], v[128:131]
    s_waitcnt vmcnt(8)
    v_mfma_f32_16x16x32_bf16 v[112:115], a[60:63], v[92:95], v[112:115]
    buffer_load_dwordx4 v[88:91], v25, s[20:23], s60 offen sc1
    v_mfma_f32_16x16x32_bf16 v[116:119], a[64:67], v[92:95], v[116:119]
    v_mfma_f32_16x16x32_bf16 v[120:123], a[68:71], v[92:95], v[120:123]
    ds_write_b128 v26, v[140:143] offset:22528
    v_mfma_f32_16x16x32_bf16 v[124:127], a[72:75], v[92:95], v[124:127]
    v_mfma_f32_16x16x32_bf16 v[128:131], a[76:79], v[92:95], v[128:131]
    s_waitcnt vmcnt(8)
    v_mfma_f32_16x16x32_bf16 v[112:115], a[80:83], v[96:99], v[112:115]
    buffer_load_dwordx4 v[92:95], v25, s[20:23], s61 offen sc1
    v_mfma_f32_16x16x32_bf16 v[116:119], a[84:87], v[96:99], v[116:119]
    v_mfma_f32_16x16x32_bf16 v[120:123], a[88:91], v[96:99], v[120:123]
    ds_write_b128 v26, v[144:147] offset:23552
    v_mfma_f32_16x16x32_bf16 v[124:127], a[92:95], v[96:99], v[124:127]
    v_mfma_f32_16x16x32_bf16 v[128:131], a[96:99], v[96:99], v[128:131]
    s_waitcnt vmcnt(8)
    v_mfma_f32_16x16x32_bf16 v[112:115], a[100:103], v[100:103], v[112:115]
    buffer_load_dwordx4 v[96:99], v25, s[20:23], s62 offen sc1
    v_mfma_f32_16x16x32_bf16 v[116:119], a[104:107], v[100:103], v[116:119]
    v_mfma_f32_16x16x32_bf16 v[120:123], a[108:111], v[100:103], v[120:123]
    ds_write_b128 v26, v[148:151] offset:24576
    v_mfma_f32_16x16x32_bf16 v[124:127], a[112:115], v[100:103], v[124:127]
    v_mfma_f32_16x16x32_bf16 v[128:131], a[116:119], v[100:103], v[128:131]
    s_waitcnt vmcnt(8)
    v_mfma_f32_16x16x32_bf16 v[112:115], a[120:123], v[64:67], v[112:115]
    buffer_load_dwordx4 v[100:103], v25, s[20:23], s63 offen sc1
    v_mfma_f32_16x16x32_bf16 v[116:119], a[124:127], v[64:67], v[116:119]
    v_mfma_f32_16x16x32_bf16 v[120:123], a[128:131], v[64:67], v[120:123]
    v_mfma_f32_16x16x32_bf16 v[124:127], a[132:135], v[64:67], v[124:127]
    v_mfma_f32_16x16x32_bf16 v[128:131], a[136:139], v[64:67], v[128:131]
    s_waitcnt vmcnt(8)
    v_mfma_f32_16x16x32_bf16 v[112:115], a[140:143], v[68:71], v[112:115]
    buffer_load_dwordx4 v[64:67], v25, s[20:23], s64 offen sc1
    s_waitcnt lgkmcnt(0)
    s_barrier
    v_mfma_f32_16x16x32_bf16 v[116:119], a[144:147], v[68:71], v[116:119]
    ds_read_b128 v[132:135], v27 offset:20480
    v_mfma_f32_16x16x32_bf16 v[120:123], a[148:151], v[68:71], v[120:123]
    v_mfma_f32_16x16x32_bf16 v[124:127], a[152:155], v[68:71], v[124:127]
    ds_read_b128 v[136:139], v27 offset:21504
    v_mfma_f32_16x16x32_bf16 v[128:131], a[156:159], v[68:71], v[128:131]
    s_waitcnt vmcnt(8)
    v_mfma_f32_16x16x32_bf16 v[112:115], a[160:163], v[72:75], v[112:115]
    buffer_load_dwordx4 v[68:71], v25, s[20:23], s65 offen sc1
    v_mfma_f32_16x16x32_bf16 v[116:119], a[164:167], v[72:75], v[116:119]
    ds_read_b128 v[140:143], v27 offset:22528
    v_mfma_f32_16x16x32_bf16 v[120:123], a[168:171], v[72:75], v[120:123]
    v_mfma_f32_16x16x32_bf16 v[124:127], a[172:175], v[72:75], v[124:127]
    ds_read_b128 v[144:147], v27 offset:23552
    v_mfma_f32_16x16x32_bf16 v[128:131], a[176:179], v[72:75], v[128:131]
    s_waitcnt vmcnt(8)
    v_mfma_f32_16x16x32_bf16 v[112:115], a[180:183], v[76:79], v[112:115]
    buffer_load_dwordx4 v[72:75], v25, s[20:23], s66 offen sc1
    v_mfma_f32_16x16x32_bf16 v[116:119], a[184:187], v[76:79], v[116:119]
    ds_read_b128 v[148:151], v27 offset:24576
    v_mfma_f32_16x16x32_bf16 v[120:123], a[188:191], v[76:79], v[120:123]
    v_mfma_f32_16x16x32_bf16 v[124:127], a[192:195], v[76:79], v[124:127]
    v_mfma_f32_16x16x32_bf16 v[128:131], a[196:199], v[76:79], v[128:131]
    s_waitcnt vmcnt(8)
    v_mfma_f32_16x16x32_bf16 v[112:115], a[200:203], v[80:83], v[112:115]
    buffer_load_dwordx4 v[76:79], v25, s[20:23], s67 offen sc1
    v_mfma_f32_16x16x32_bf16 v[116:119], a[204:207], v[80:83], v[116:119]
    v_mfma_f32_16x16x32_bf16 v[120:123], a[208:211], v[80:83], v[120:123]
    v_mfma_f32_16x16x32_bf16 v[124:127], a[212:215], v[80:83], v[124:127]
    v_mfma_f32_16x16x32_bf16 v[128:131], a[216:219], v[80:83], v[128:131]
    s_waitcnt vmcnt(8)
    v_mfma_f32_16x16x32_bf16 v[112:115], a[220:223], v[84:87], v[112:115]
    buffer_load_dwordx4 v[80:83], v25, s[20:23], s68 offen sc1
    v_mfma_f32_16x16x32_bf16 v[116:119], a[224:227], v[84:87], v[116:119]
    v_mfma_f32_16x16x32_bf16 v[120:123], a[228:231], v[84:87], v[120:123]
    v_mfma_f32_16x16x32_bf16 v[124:127], a[232:235], v[84:87], v[124:127]
    v_mfma_f32_16x16x32_bf16 v[128:131], a[236:239], v[84:87], v[128:131]
    s_waitcnt vmcnt(8)
    s_waitcnt lgkmcnt(4)
    v_mfma_f32_16x16x32_bf16 v[132:135], a[0:3], v[88:91], v[132:135]
    buffer_load_dwordx4 v[84:87], v25, s[20:23], s69 offen sc1
    s_waitcnt lgkmcnt(3)
    v_mfma_f32_16x16x32_bf16 v[136:139], a[4:7], v[88:91], v[136:139]
    s_waitcnt lgkmcnt(2)
    v_mfma_f32_16x16x32_bf16 v[140:143], a[8:11], v[88:91], v[140:143]
    s_waitcnt lgkmcnt(1)
    v_mfma_f32_16x16x32_bf16 v[144:147], a[12:15], v[88:91], v[144:147]
    s_waitcnt lgkmcnt(0)
    v_mfma_f32_16x16x32_bf16 v[148:151], a[16:19], v[88:91], v[148:151]
    s_waitcnt vmcnt(8)
    v_mfma_f32_16x16x32_bf16 v[132:135], a[20:23], v[92:95], v[132:135]
    buffer_load_dwordx4 v[88:91], v25, s[20:23], s70 offen sc1
    v_mfma_f32_16x16x32_bf16 v[136:139], a[24:27], v[92:95], v[136:139]
    v_mfma_f32_16x16x32_bf16 v[140:143], a[28:31], v[92:95], v[140:143]
    ds_write_b128 v26, v[112:115] offset:40960
    v_mfma_f32_16x16x32_bf16 v[144:147], a[32:35], v[92:95], v[144:147]
    v_mfma_f32_16x16x32_bf16 v[148:151], a[36:39], v[92:95], v[148:151]
    s_waitcnt vmcnt(8)
    v_mfma_f32_16x16x32_bf16 v[132:135], a[40:43], v[96:99], v[132:135]
    buffer_load_dwordx4 v[92:95], v25, s[20:23], s71 offen sc1
    v_mfma_f32_16x16x32_bf16 v[136:139], a[44:47], v[96:99], v[136:139]
    v_mfma_f32_16x16x32_bf16 v[140:143], a[48:51], v[96:99], v[140:143]
    ds_write_b128 v26, v[116:119] offset:41984
    v_mfma_f32_16x16x32_bf16 v[144:147], a[52:55], v[96:99], v[144:147]
    v_mfma_f32_16x16x32_bf16 v[148:151], a[56:59], v[96:99], v[148:151]
    s_waitcnt vmcnt(8)
    v_mfma_f32_16x16x32_bf16 v[132:135], a[60:63], v[100:103], v[132:135]
    v_mfma_f32_16x16x32_bf16 v[136:139], a[64:67], v[100:103], v[136:139]
    v_mfma_f32_16x16x32_bf16 v[140:143], a[68:71], v[100:103], v[140:143]
    ds_write_b128 v26, v[120:123] offset:43008
    v_mfma_f32_16x16x32_bf16 v[144:147], a[72:75], v[100:103], v[144:147]
    v_mfma_f32_16x16x32_bf16 v[148:151], a[76:79], v[100:103], v[148:151]
    s_waitcnt vmcnt(7)
    v_mfma_f32_16x16x32_bf16 v[132:135], a[80:83], v[64:67], v[132:135]
    v_mfma_f32_16x16x32_bf16 v[136:139], a[84:87], v[64:67], v[136:139]
    v_mfma_f32_16x16x32_bf16 v[140:143], a[88:91], v[64:67], v[140:143]
    ds_write_b128 v26, v[124:127] offset:44032
    v_mfma_f32_16x16x32_bf16 v[144:147], a[92:95], v[64:67], v[144:147]
    v_mfma_f32_16x16x32_bf16 v[148:151], a[96:99], v[64:67], v[148:151]
    s_waitcnt vmcnt(6)
    v_mfma_f32_16x16x32_bf16 v[132:135], a[100:103], v[68:71], v[132:135]
    v_mfma_f32_16x16x32_bf16 v[136:139], a[104:107], v[68:71], v[136:139]
    v_mfma_f32_16x16x32_bf16 v[140:143], a[108:111], v[68:71], v[140:143]
    ds_write_b128 v26, v[128:131] offset:45056
    v_mfma_f32_16x16x32_bf16 v[144:147], a[112:115], v[68:71], v[144:147]
    v_mfma_f32_16x16x32_bf16 v[148:151], a[116:119], v[68:71], v[148:151]
    s_waitcnt vmcnt(5)
    v_mfma_f32_16x16x32_bf16 v[132:135], a[120:123], v[72:75], v[132:135]
    v_mfma_f32_16x16x32_bf16 v[136:139], a[124:127], v[72:75], v[136:139]
    v_mfma_f32_16x16x32_bf16 v[140:143], a[128:131], v[72:75], v[140:143]
    v_mfma_f32_16x16x32_bf16 v[144:147], a[132:135], v[72:75], v[144:147]
    v_mfma_f32_16x16x32_bf16 v[148:151], a[136:139], v[72:75], v[148:151]
    s_waitcnt vmcnt(4)
    v_mfma_f32_16x16x32_bf16 v[132:135], a[140:143], v[76:79], v[132:135]
    s_waitcnt lgkmcnt(0)
    s_barrier
    v_mfma_f32_16x16x32_bf16 v[136:139], a[144:147], v[76:79], v[136:139]
    ds_read_b128 v[112:115], v28 offset:40960
    v_mfma_f32_16x16x32_bf16 v[140:143], a[148:151], v[76:79], v[140:143]
    v_mfma_f32_16x16x32_bf16 v[144:147], a[152:155], v[76:79], v[144:147]
    ds_read_b128 v[116:119], v28 offset:41984
    v_mfma_f32_16x16x32_bf16 v[148:151], a[156:159], v[76:79], v[148:151]
    s_waitcnt vmcnt(3)
    v_mfma_f32_16x16x32_bf16 v[132:135], a[160:163], v[80:83], v[132:135]
    v_mfma_f32_16x16x32_bf16 v[136:139], a[164:167], v[80:83], v[136:139]
    ds_read_b128 v[120:123], v28 offset:43008
    v_mfma_f32_16x16x32_bf16 v[140:143], a[168:171], v[80:83], v[140:143]
    v_mfma_f32_16x16x32_bf16 v[144:147], a[172:175], v[80:83], v[144:147]
    ds_read_b128 v[124:127], v28 offset:44032
    v_mfma_f32_16x16x32_bf16 v[148:151], a[176:179], v[80:83], v[148:151]
    s_waitcnt vmcnt(2)
    v_mfma_f32_16x16x32_bf16 v[132:135], a[180:183], v[84:87], v[132:135]
    v_mfma_f32_16x16x32_bf16 v[136:139], a[184:187], v[84:87], v[136:139]
    ds_read_b128 v[128:131], v28 offset:45056
    v_mfma_f32_16x16x32_bf16 v[140:143], a[188:191], v[84:87], v[140:143]
    v_mfma_f32_16x16x32_bf16 v[144:147], a[192:195], v[84:87], v[144:147]
    v_mfma_f32_16x16x32_bf16 v[148:151], a[196:199], v[84:87], v[148:151]
    s_waitcnt vmcnt(1)
    v_mfma_f32_16x16x32_bf16 v[132:135], a[200:203], v[88:91], v[132:135]
    v_mfma_f32_16x16x32_bf16 v[136:139], a[204:207], v[88:91], v[136:139]
    v_mfma_f32_16x16x32_bf16 v[140:143], a[208:211], v[88:91], v[140:143]
    v_mfma_f32_16x16x32_bf16 v[144:147], a[212:215], v[88:91], v[144:147]
    v_mfma_f32_16x16x32_bf16 v[148:151], a[216:219], v[88:91], v[148:151]
    s_waitcnt vmcnt(0)
    v_mfma_f32_16x16x32_bf16 v[132:135], a[220:223], v[92:95], v[132:135]
    v_mfma_f32_16x16x32_bf16 v[136:139], a[224:227], v[92:95], v[136:139]
    v_mfma_f32_16x16x32_bf16 v[140:143], a[228:231], v[92:95], v[140:143]
    v_mfma_f32_16x16x32_bf16 v[144:147], a[232:235], v[92:95], v[144:147]
    v_mfma_f32_16x16x32_bf16 v[148:151], a[236:239], v[92:95], v[148:151]
    s_waitcnt lgkmcnt(0)
    s_nop 7
    v_pk_add_f32 v[132:133], v[132:133], v[112:113]
    v_pk_add_f32 v[134:135], v[134:135], v[114:115]
    v_cvt_pk_bf16_f32 v44, v132, v133
    v_cvt_pk_bf16_f32 v45, v134, v135
    ds_write_b64 v29, v[44:45] offset:0
    v_pk_add_f32 v[136:137], v[136:137], v[116:117]
    v_pk_add_f32 v[138:139], v[138:139], v[118:119]
    v_cvt_pk_bf16_f32 v46, v136, v137
    v_cvt_pk_bf16_f32 v47, v138, v139
    ds_write_b64 v29, v[46:47] offset:32
    v_pk_add_f32 v[140:141], v[140:141], v[120:121]
    v_pk_add_f32 v[142:143], v[142:143], v[122:123]
    v_cvt_pk_bf16_f32 v48, v140, v141
    v_cvt_pk_bf16_f32 v49, v142, v143
    ds_write_b64 v29, v[48:49] offset:64
    v_pk_add_f32 v[144:145], v[144:145], v[124:125]
    v_pk_add_f32 v[146:147], v[146:147], v[126:127]
    v_cvt_pk_bf16_f32 v50, v144, v145
    v_cvt_pk_bf16_f32 v51, v146, v147
    ds_write_b64 v29, v[50:51] offset:96
    v_pk_add_f32 v[148:149], v[148:149], v[128:129]
    v_pk_add_f32 v[150:151], v[150:151], v[130:131]
    v_cvt_pk_bf16_f32 v52, v148, v149
    v_cvt_pk_bf16_f32 v53, v150, v151
    ds_write_b64 v29, v[52:53] offset:128
    ds_read_b128 v[64:67], v30
    ds_read_b128 v[68:71], v31
    ds_read_b128 v[72:75], v32
    s_waitcnt lgkmcnt(2)
    buffer_store_dwordx4 v[64:67], v33, s[24:27], 0 offen
    s_waitcnt lgkmcnt(1)
    buffer_store_dwordx4 v[68:71], v34, s[24:27], 0 offen
    s_waitcnt lgkmcnt(0)
    buffer_store_dwordx4 v[72:75], v35, s[24:27], 0 offen
    s_endpgm
L_pathB:
    s_lshl_b32 s33, s50, 1
    s_add_u32 s33, s33, s49
    s_lshl_b32 s33, s33, 1
    s_add_u32 s33, s33, s51
    s_sub_u32 s33, s33, 30
    s_mul_i32 s34, s33, 5
    s_lshr_b32 s34, s34, 3
    s_sub_u32 s55, s34, 10
    s_cmp_ge_u32 s34, 10
    s_cselect_b32 s34, s55, s34
    s_lshl_b32 s35, s34, 7
    s_mul_i32 s36, s34, 196608
    s_mul_i32 s55, s33, 192
    s_mul_i32 s56, s54, 49152
    s_add_u32 s55, s55, s56
    v_add_u32 v44, 0, v1
    v_mul_u32_u24 v45, 171, v44
    v_lshrrev_b32 v45, 11, v45
    v_mul_u32_u24 v48, 12, v45
    v_sub_u32 v44, v44, v48
    v_lshrrev_b32 v48, 3, v45
    v_bfe_u32 v49, v44, 2, 1
    v_xor_b32 v49, 1, v49
    v_lshlrev_b32 v48, v49, v48
    v_xor_b32 v44, v44, v48
    v_mul_u32_u24 v45, 3072, v45
    v_lshl_add_u32 v44, v44, 4, v45
    v_add_u32 v8, s55, v44
    s_sub_u32 s55, s55, 1024
    v_add_u32 v44, 64, v1
    v_mul_u32_u24 v45, 171, v44
    v_lshrrev_b32 v45, 11, v45
    v_mul_u32_u24 v48, 12, v45
    v_sub_u32 v44, v44, v48
    v_lshrrev_b32 v48, 3, v45
    v_bfe_u32 v49, v44, 2, 1
    v_xor_b32 v49, 1, v49
    v_lshlrev_b32 v48, v49, v48
    v_xor_b32 v44, v44, v48
    v_mul_u32_u24 v45, 3072, v45
    v_lshl_add_u32 v44, v44, 4, v45
    v_add_u32 v9, s55, v44
    s_sub_u32 s55, s55, 1024
    v_add_u32 v44, 128, v1
    v_mul_u32_u24 v45, 171, v44
    v_lshrrev_b32 v45, 11, v45
    v_mul_u32_u24 v48, 12, v45
    v_sub_u32 v44, v44, v48
    v_lshrrev_b32 v48, 3, v45
    v_bfe_u32 v49, v44, 2, 1
    v_xor_b32 v49, 1, v49
    v_lshlrev_b32 v48, v49, v48
    v_xor_b32 v44, v44, v48
    v_mul_u32_u24 v45, 3072, v45
    v_lshl_add_u32 v44, v44, 4, v45
    v_add_u32 v7, s55, v44
    s_sub_u32 s55, s55, 1024
    s_mov_b32 s57, 1920
    v_lshrrev_b32 v44, 4, v1
    v_xor_b32 v44, v44, v46
    s_mul_i32 s55, s32, 32
    s_add_u32 s55, s55, s57
    v_add_u32 v45, s55, v47
    v_mul_u32_u24 v45, 1280, v45
    v_lshl_add_u32 v2, v44, 4, v45
    v_xor_b32 v44, 64, v2
    v_add_u32 v3, 9216, v44
    v_add_u32 v4, 20480, v2
    v_add_u32 v5, 29696, v44
    s_mul_i32 s37, s32, 4096
    s_mul_i32 s38, s53, 6144
    s_mul_i32 s55, s54, 3072
    s_add_u32 s38, s38, s55
    s_waitcnt lgkmcnt(0)
    s_bitcmp1_b32 s32, 0
    s_cselect_b32 s12, s64, s62
    s_cselect_b32 s13, s65, s63
    s_and_b32 s13, s13, 0xffff
    s_mov_b32 s14, 1966080
    s_mov_b32 s15, 0x20000
    s_mov_b32 s8, s60
    s_and_b32 s9, s61, 0xffff
    s_mov_b32 s10, 2621440
    s_mov_b32 s11, 0x20000
    s_add_u32 m0, s38, 49152
    s_nop 0
    buffer_load_dwordx4 v8, s[12:15], s36 offen lds
    buffer_load_dwordx4 v9, s[12:15], s36 offen offset:1024 lds
    buffer_load_dwordx4 v7, s[12:15], s36 offen offset:2048 lds
    s_add_u32 m0, s37, 0
    s_nop 0
    buffer_load_dwordx4 v2, s[8:11], s35 offen  lds
    buffer_load_dwordx4 v3, s[8:11], s35 offen offset:1024  lds
    s_add_u32 m0, s37, 2048
    s_nop 0
    buffer_load_dwordx4 v4, s[8:11], s35 offen  lds
    buffer_load_dwordx4 v5, s[8:11], s35 offen offset:1024  lds
    s_add_u32 s36, s36, 98304
    s_add_u32 m0, s38, 61440
    s_nop 0
    buffer_load_dwordx4 v8, s[12:15], s36 offen lds
    buffer_load_dwordx4 v9, s[12:15], s36 offen offset:1024 lds
    buffer_load_dwordx4 v7, s[12:15], s36 offen offset:2048 lds
    s_mov_b32 s20, s6
    s_and_b32 s21, s7, 0xffff
    s_mov_b32 s22, 8323072
    s_mov_b32 s23, 0x20000
    s_and_b32 s49, s32, 1
    s_lshr_b32 s50, s32, 1
    v_and_b32 v49, 15, v1
    s_lshl_b32 s51, s50, 6
    v_add_u32 v44, s51, v49
    v_lshlrev_b32 v44, 7, v44
    v_bfe_u32 v45, v1, 1, 3
    v_lshrrev_b32 v46, 4, v1
    v_xor_b32 v45, v45, v46
    v_lshl_add_u32 v10, v45, 4, v44
    v_xor_b32 v11, 64, v10
    v_bfe_u32 v47, v1, 2, 2
    v_lshl_add_u32 v44, v46, 3, v47
    v_mul_u32_u24 v44, 192, v44
    v_bfe_u32 v47, v1, 4, 1
    v_and_b32 v48, 3, v1
    v_lshl_add_u32 v45, v48, 3, v44
    s_lshl_b32 s51, s49, 7
    s_add_u32 s51, s51, 49152
    v_add_u32 v45, s51, v45
    v_lshl_add_u32 v14, v47, 5, v45
    v_xor_b32 v48, 1, v47
    v_lshl_add_u32 v15, v48, 5, v45
    v_and_b32 v48, 1, v1
    v_lshl_add_u32 v44, v48, 5, v44
    v_bfe_u32 v48, v1, 1, 1
    v_lshl_add_u32 v44, v48, 3, v44
    v_xor_b32 v48, s49, v47
    v_lshl_add_u32 v44, v48, 4, v44
    v_add_u32 v16, 49216, v44
    v_lshlrev_b32 v17, 4, v1
    v_lshlrev_b32 v44, 10, v47
    v_lshrrev_b32 v48, 5, v1
    v_lshl_add_u32 v44, v48, 8, v44
    v_lshl_add_u32 v44, v49, 4, v44
    s_lshl_b32 s51, s49, 9
    v_add_u32 v156, s51, v44
    s_mul_i32 s54, s33, 12288
    s_add_u32 s55, s50, 30
    s_mul_i32 s55, s55, 196608
    s_add_u32 s54, s54, s55
    s_lshl_b32 s51, s49, 13
    s_add_u32 s51, s51, s54
    s_add_u32 s41, s51, 0
    s_add_u32 s42, s51, 1024
    s_add_u32 s43, s51, 2048
    s_add_u32 s44, s51, 3072
    s_add_u32 s45, s54, 4096
    s_add_u32 s46, s54, 6144
    s_lshl_b32 s51, s33, 7
    s_add_u32 s7, s51, 6322176
    s_mov_b32 s24, s68
    s_and_b32 s25, s69, 0xffff
    s_mov_b32 s26, 2621440
    s_mov_b32 s27, 0x20000
    s_mov_b32 s28, s70
    s_and_b32 s29, s71, 0xffff
    s_mov_b32 s30, 256
    s_mov_b32 s31, 0x20000
    v_lshrrev_b32 v46, 4, v1
    v_and_b32 v50, 15, v1
    s_cmp_eq_u32 s32, 0
    s_cselect_b32 s7, s7, 1073741824
    s_sub_u32 s51, s7, 128
    v_mov_b32 v44, s51
    v_mov_b32 v45, 1073741824
    v_cmp_gt_u32 vcc, 8, v1
    v_lshlrev_b32 v47, 4, v1
    s_nop 0
    v_cndmask_b32 v44, v44, v45, vcc
    v_add_u32 v38, v44, v47
    s_mov_b32 s60, s35
    s_cmp_gt_u32 s35, 0
    s_cselect_b32 s61, 0, 128
    s_mov_b32 s57, 128
    s_mov_b32 s56, 256
    s_cmp_gt_u32 s35, 128
    s_cselect_b32 s62, s57, s56
    s_mov_b32 s57, 256
    s_mov_b32 s56, 384
    s_cmp_gt_u32 s35, 256
    s_cselect_b32 s63, s57, s56
    s_mov_b32 s57, 384
    s_mov_b32 s56, 512
    s_cmp_gt_u32 s35, 384
    s_cselect_b32 s64, s57, s56
    s_mov_b32 s57, 512
    s_mov_b32 s56, 640
    s_cmp_gt_u32 s35, 512
    s_cselect_b32 s65, s57, s56
    s_mov_b32 s57, 640
    s_mov_b32 s56, 768
    s_cmp_gt_u32 s35, 640
    s_cselect_b32 s66, s57, s56
    s_mov_b32 s57, 768
    s_mov_b32 s56, 896
    s_cmp_gt_u32 s35, 768
    s_cselect_b32 s67, s57, s56
    s_mov_b32 s57, 896
    s_mov_b32 s56, 1024
    s_cmp_gt_u32 s35, 896
    s_cselect_b32 s68, s57, s56
    s_mov_b32 s57, 1024
    s_mov_b32 s56, 1152
    s_cmp_gt_u32 s35, 1024
    s_cselect_b32 s69, s57, s56
    s_mov_b32 s57, 1152
    s_mov_b32 s56, 1280
    s_mov_b32 s58, 0xbfb8aa3b
    s_mov_b32 s59, 0xbfb8aa3b
    v_lshlrev_b32 v20, 4, v1
    v_lshrrev_b32 v46, 4, v1
    v_and_b32 v50, 15, v1
    s_and_b32 s49, s2, 7
    s_lshr_b32 s50, s2, 3
    s_lshr_b32 s56, s49, 1
    s_lshl_b32 s56, s56, 3
    s_lshr_b32 s51, s50, 2
    s_add_u32 s56, s56, s51
    s_and_b32 s57, s49, 1
    s_lshl_b32 s57, s57, 2
    s_and_b32 s52, s50, 3
    s_add_u32 s57, s57, s52
    s_mul_i32 s51, s51, 3
    s_lshr_b32 s51, s51, 1
    s_bfe_u32 s51, s50, 0x10002
    s_mul_i32 s51, s51, 6
    s_and_b32 s52, s57, 1
    s_mul_i32 s52, s52, 0
    s_add_u32 s52, s52, s51
    s_sub_u32 s51, s52, 12
    s_cmp_ge_u32 s52, 12
    s_cselect_b32 s52, s51, s52
    s_mul_i32 s53, s32, 12
    s_mul_i32 s54, s57, 48
    s_add_u32 s54, s54, s53
    s_mul_i32 s40, s54, 5120
    s_add_u32 s40, s40, 6356992
    s_mul_i32 s55, s52, 5120
    s_add_u32 s39, s40, s55
    s_add_u32 s40, s40, 61440
    s_mul_i32 s54, s56, 48
    s_add_u32 s54, s54, s53
    s_lshl_b32 s54, s54, 12
    s_mov_b32 s33, s54
    s_lshl_b32 s52, s52, 12
    s_add_u32 s70, s54, s52
    v_add_u32 v21, 4096, v20
    s_add_u32 s51, s32, 1
    s_and_b32 s51, s51, 3
    s_lshl_b32 s51, s51, 10
    v_add_u32 v22, s51, v20
    s_add_u32 s51, s32, 2
    s_and_b32 s51, s51, 3
    s_lshl_b32 s51, s51, 10
    v_add_u32 v23, s51, v20
    s_add_u32 s51, s32, 3
    s_and_b32 s51, s51, 3
    s_lshl_b32 s51, s51, 10
    v_add_u32 v24, s51, v20
    s_add_u32 s51, s32, 4
    s_and_b32 s51, s51, 3
    s_lshl_b32 s51, s51, 10
    v_add_u32 v25, s51, v20
    s_mul_i32 s51, s32, 5120
    v_add_u32 v26, s51, v20
    s_xor_b32 s51, s32, 2
    s_mul_i32 s51, s51, 5120
    v_add_u32 v27, s51, v20
    s_add_u32 s51, s32, 1
    s_and_b32 s51, s51, 3
    s_mul_i32 s51, s51, 5120
    v_add_u32 v28, s51, v20
    s_mul_i32 s55, s32, 2816
    s_add_u32 s55, s55, 61440
    v_mul_u32_u24 v44, 176, v50
    v_lshl_add_u32 v44, v46, 3, v44
    v_add_u32 v29, s55, v44
    s_lshl_b32 s53, s56, 2
    s_add_u32 s53, s53, s32
    s_mul_i32 s53, s53, 20480
    s_mul_i32 s54, s57, 160
    s_add_u32 s53, s53, s54
    v_add_u32 v44, 0, v1
    v_mul_u32_u24 v45, 205, v44
    v_lshrrev_b32 v45, 11, v45
    v_mul_u32_u24 v47, 10, v45
    v_sub_u32 v47, v44, v47
    v_lshlrev_b32 v47, 4, v47
    v_mul_u32_u24 v48, 176, v45
    v_add3_u32 v30, v48, v47, s55
    v_mul_u32_u24 v48, 1280, v45
    v_add3_u32 v33, v48, v47, s53
    v_add_u32 v44, 64, v1
    v_mul_u32_u24 v45, 205, v44
    v_lshrrev_b32 v45, 11, v45
    v_mul_u32_u24 v47, 10, v45
    v_sub_u32 v47, v44, v47
    v_lshlrev_b32 v47, 4, v47
    v_mul_u32_u24 v48, 176, v45
    v_add3_u32 v31, v48, v47, s55
    v_mul_u32_u24 v48, 1280, v45
    v_add3_u32 v34, v48, v47, s53
    v_add_u32 v44, 128, v1
    v_mul_u32_u24 v45, 205, v44
    v_lshrrev_b32 v45, 11, v45
    v_mul_u32_u24 v47, 10, v45
    v_sub_u32 v47, v44, v47
    v_lshlrev_b32 v47, 4, v47
    v_mul_u32_u24 v48, 176, v45
    v_add3_u32 v32, v48, v47, s55
    v_mul_u32_u24 v48, 1280, v45
    v_add3_u32 v35, v48, v47, s53
    v_lshrrev_b32 v44, 5, v1
    v_lshlrev_b32 v44, 30, v44
    v_add_u32 v35, v35, v44
    s_mul_i32 s51, s56, 86
    s_lshr_b32 s51, s51, 8
    s_mul_i32 s51, s51, 24
    s_cmp_ge_u32 s56, 30
    s_cselect_b32 s52, 4, 6
    s_mul_i32 s53, s52, s32
    s_add_u32 s51, s51, s53
    s_sub_u32 s52, s52, 1
    s_lshl_b32 s51, s51, 7
    s_add_u32 s51, s51, 6291456
    v_min_u32 v44, s52, v1
    v_lshlrev_b32 v44, 7, v44
    v_add_u32 v36, s51, v44
    s_mul_i32 s51, s57, 5
    s_add_u32 s52, s51, 4
    s_lshr_b32 s51, s51, 3
    s_lshr_b32 s52, s52, 3
    s_sub_u32 s52, s52, s51
    s_mul_i32 s52, s52, 6144
    s_lshl_b32 s51, s51, 2
    s_add_u32 s51, s51, s32
    s_mul_i32 s51, s51, 1536
    s_add_u32 s51, s51, 6324224
    v_and_b32 v44, 31, v1
    v_min_u32 v44, 11, v44
    v_lshlrev_b32 v44, 7, v44
    v_lshrrev_b32 v45, 5, v1
    v_mul_u32_u24 v45, s52, v45
    v_add3_u32 v37, v44, v45, s51
    v_mov_b32 v44, 0
    v_mov_b32 v45, 0
    v_mov_b32 v46, 0
    v_mov_b32 v47, 0
    s_mov_b64 exec, 0xff
    buffer_store_dwordx4 v[44:47], v20, s[20:23], s7 offen sc1
    s_mov_b64 exec, -1
    s_add_u32 m0, s37, 16384
    s_nop 0
    buffer_load_dwordx4 v2, s[8:11], s61 offen  lds
    buffer_load_dwordx4 v3, s[8:11], s61 offen offset:1024  lds
    s_add_u32 m0, s37, 18432
    s_nop 0
    buffer_load_dwordx4 v4, s[8:11], s61 offen  lds
    s_waitcnt vmcnt(7)
    s_barrier
    ds_read_b128 v[88:91], v10 offset:0
    ds_read_b64_tr_b16 v[64:65], v14 offset:0
    ds_read_b64_tr_b16 v[66:67], v14 offset:768
    ds_read_b64_tr_b16 v[68:69], v15 offset:0
    ds_read_b64_tr_b16 v[70:71], v15 offset:768
    ds_read_b64_tr_b16 v[72:73], v16 offset:0
    ds_read_b64_tr_b16 v[74:75], v16 offset:768
    ds_read_b64_tr_b16 v[76:77], v14 offset:6144
    ds_read_b64_tr_b16 v[78:79], v14 offset:6912
    ds_read_b64_tr_b16 v[80:81], v15 offset:6144
    ds_read_b64_tr_b16 v[82:83], v15 offset:6912
    ds_read_b64_tr_b16 v[84:85], v16 offset:6144
    ds_read_b64_tr_b16 v[86:87], v16 offset:6912
    ds_read_b128 v[92:95], v10 offset:2048
    ds_read_b128 v[96:99], v10 offset:4096
    ds_read_b128 v[100:103], v10 offset:6144
    s_waitcnt lgkmcnt(13)
    v_mfma_f32_16x16x32_bf16 v[160:163], v[64:67], v[88:91], 0
    s_waitcnt lgkmcnt(11)
    v_mfma_f32_16x16x32_bf16 v[164:167], v[68:71], v[88:91], 0
    buffer_load_dwordx4 v5, s[8:11], s61 offen offset:1024  lds
    s_waitcnt lgkmcnt(9)
    v_mfma_f32_16x16x32_bf16 v[224:227], v[72:75], v[88:91], 0
    s_mul_i32 s36, s61, 1536
    s_add_u32 m0, s38, 73728
    s_waitcnt lgkmcnt(7)
    v_mfma_f32_16x16x32_bf16 v[168:171], v[76:79], v[88:91], 0
    buffer_load_dwordx4 v8, s[12:15], s36 offen lds
    s_waitcnt lgkmcnt(5)
    v_mfma_f32_16x16x32_bf16 v[172:175], v[80:83], v[88:91], 0
    s_waitcnt lgkmcnt(3)
    v_mfma_f32_16x16x32_bf16 v[232:235], v[84:87], v[88:91], 0
    buffer_load_dwordx4 v9, s[12:15], s36 offen offset:1024 lds
    s_waitcnt lgkmcnt(2)
    v_mfma_f32_16x16x32_bf16 v[176:179], v[64:67], v[92:95], 0
    s_waitcnt lgkmcnt(0)
    v_mfma_f32_16x16x32_bf16 v[180:183], v[68:71], v[92:95], 0
    s_waitcnt vmcnt(7)
    s_barrier
    v_mfma_f32_16x16x32_bf16 v[228:231], v[72:75], v[92:95], 0
    ds_read_b128 v[128:131], v11 offset:0
    v_mfma_f32_16x16x32_bf16 v[184:187], v[76:79], v[92:95], 0
    ds_read_b64_tr_b16 v[104:105], v14 offset:12288
    v_mfma_f32_16x16x32_bf16 v[188:191], v[80:83], v[92:95], 0
    buffer_load_dwordx4 v7, s[12:15], s36 offen offset:2048 lds
    ds_read_b64_tr_b16 v[106:107], v14 offset:13056
    v_mfma_f32_16x16x32_bf16 v[236:239], v[84:87], v[92:95], 0
    ds_read_b64_tr_b16 v[108:109], v15 offset:12288
    v_mfma_f32_16x16x32_bf16 v[192:195], v[64:67], v[96:99], 0
    ds_read_b64_tr_b16 v[110:111], v15 offset:13056
    s_add_u32 m0, s37, 32768
    v_mfma_f32_16x16x32_bf16 v[196:199], v[68:71], v[96:99], 0
    buffer_load_dwordx4 v2, s[8:11], s62 offen  lds
    ds_read_b64_tr_b16 v[112:113], v16 offset:12288
    v_mfma_f32_16x16x32_bf16 v[240:243], v[72:75], v[96:99], 0
    ds_read_b64_tr_b16 v[114:115], v16 offset:13056
    v_mfma_f32_16x16x32_bf16 v[200:203], v[76:79], v[96:99], 0
    ds_read_b64_tr_b16 v[116:117], v14 offset:18432
    v_mfma_f32_16x16x32_bf16 v[204:207], v[80:83], v[96:99], 0
    buffer_load_dwordx4 v3, s[8:11], s62 offen offset:1024  lds
    ds_read_b64_tr_b16 v[118:119], v14 offset:19200
    v_mfma_f32_16x16x32_bf16 v[248:251], v[84:87], v[96:99], 0
    ds_read_b64_tr_b16 v[120:121], v15 offset:18432
    v_mfma_f32_16x16x32_bf16 v[208:211], v[64:67], v[100:103], 0
    ds_read_b64_tr_b16 v[122:123], v15 offset:19200
    s_add_u32 s36, s36, 98304
    s_add_u32 m0, s38, 86016
    v_mfma_f32_16x16x32_bf16 v[212:215], v[68:71], v[100:103], 0
    buffer_load_dwordx4 v8, s[12:15], s36 offen lds
    ds_read_b64_tr_b16 v[124:125], v16 offset:18432
    v_mfma_f32_16x16x32_bf16 v[244:247], v[72:75], v[100:103], 0
    ds_read_b64_tr_b16 v[126:127], v16 offset:19200
    v_mfma_f32_16x16x32_bf16 v[216:219], v[76:79], v[100:103], 0
    ds_read_b128 v[132:135], v11 offset:2048
    v_mfma_f32_16x16x32_bf16 v[220:223], v[80:83], v[100:103], 0
    buffer_load_dwordx4 v9, s[12:15], s36 offen offset:1024 lds
    ds_read_b128 v[136:139], v11 offset:4096
    v_mfma_f32_16x16x32_bf16 v[252:255], v[84:87], v[100:103], 0
    ds_read_b128 v[140:143], v11 offset:6144
    s_waitcnt lgkmcnt(13)
    v_mfma_f32_16x16x32_bf16 v[160:163], v[104:107], v[128:131], v[160:163]
    s_waitcnt lgkmcnt(11)
    v_mfma_f32_16x16x32_bf16 v[164:167], v[108:111], v[128:131], v[164:167]
    buffer_load_dwordx4 v7, s[12:15], s36 offen offset:2048 lds
    s_add_u32 m0, s37, 34816
    s_waitcnt lgkmcnt(9)
    v_mfma_f32_16x16x32_bf16 v[224:227], v[112:115], v[128:131], v[224:227]
    buffer_load_dwordx4 v4, s[8:11], s62 offen  lds
    s_waitcnt lgkmcnt(7)
    v_mfma_f32_16x16x32_bf16 v[168:171], v[116:119], v[128:131], v[168:171]
    buffer_load_dwordx4 v5, s[8:11], s62 offen offset:1024  lds
    s_waitcnt lgkmcnt(5)
    v_mfma_f32_16x16x32_bf16 v[172:175], v[120:123], v[128:131], v[172:175]
    s_mul_i32 s36, s62, 1536
    s_add_u32 m0, s38, 98304
    s_waitcnt lgkmcnt(3)
    v_mfma_f32_16x16x32_bf16 v[232:235], v[124:127], v[128:131], v[232:235]
    buffer_load_dwordx4 v8, s[12:15], s36 offen lds
    s_waitcnt lgkmcnt(2)
    v_mfma_f32_16x16x32_bf16 v[176:179], v[104:107], v[132:135], v[176:179]
    buffer_load_dwordx4 v9, s[12:15], s36 offen offset:1024 lds
    s_waitcnt lgkmcnt(0)
    v_mfma_f32_16x16x32_bf16 v[180:183], v[108:111], v[132:135], v[180:183]
    s_waitcnt vmcnt(9)
    s_barrier
    v_mfma_f32_16x16x32_bf16 v[228:231], v[112:115], v[132:135], v[228:231]
    ds_read_b128 v[88:91], v10 offset:16384
    v_mfma_f32_16x16x32_bf16 v[184:187], v[116:119], v[132:135], v[184:187]
    ds_read_b64_tr_b16 v[64:65], v14 offset:24576
    v_mfma_f32_16x16x32_bf16 v[188:191], v[120:123], v[132:135], v[188:191]
    ds_read_b64_tr_b16 v[66:67], v14 offset:25344
    v_mfma_f32_16x16x32_bf16 v[236:239], v[124:127], v[132:135], v[236:239]
    ds_read_b64_tr_b16 v[68:69], v15 offset:24576
    v_mfma_f32_16x16x32_bf16 v[192:195], v[104:107], v[136:139], v[192:195]
    ds_read_b64_tr_b16 v[70:71], v15 offset:25344
    v_mfma_f32_16x16x32_bf16 v[196:199], v[108:111], v[136:139], v[196:199]
    buffer_load_dwordx4 v7, s[12:15], s36 offen offset:2048 lds
    ds_read_b64_tr_b16 v[72:73], v16 offset:24576
    v_mfma_f32_16x16x32_bf16 v[240:243], v[112:115], v[136:139], v[240:243]
    ds_read_b64_tr_b16 v[74:75], v16 offset:25344
    v_mfma_f32_16x16x32_bf16 v[200:203], v[116:119], v[136:139], v[200:203]
    ds_read_b64_tr_b16 v[76:77], v14 offset:30720
    s_add_u32 m0, s37, 0
    v_mfma_f32_16x16x32_bf16 v[204:207], v[120:123], v[136:139], v[204:207]
    buffer_load_dwordx4 v2, s[8:11], s63 offen  lds
    ds_read_b64_tr_b16 v[78:79], v14 offset:31488
    v_mfma_f32_16x16x32_bf16 v[248:251], v[124:127], v[136:139], v[248:251]
    ds_read_b64_tr_b16 v[80:81], v15 offset:30720
    v_mfma_f32_16x16x32_bf16 v[208:211], v[104:107], v[140:143], v[208:211]
    ds_read_b64_tr_b16 v[82:83], v15 offset:31488
    v_mfma_f32_16x16x32_bf16 v[212:215], v[108:111], v[140:143], v[212:215]
    buffer_load_dwordx4 v3, s[8:11], s63 offen offset:1024  lds
    ds_read_b64_tr_b16 v[84:85], v16 offset:30720
    v_mfma_f32_16x16x32_bf16 v[244:247], v[112:115], v[140:143], v[244:247]
    ds_read_b64_tr_b16 v[86:87], v16 offset:31488
    v_mfma_f32_16x16x32_bf16 v[216:219], v[116:119], v[140:143], v[216:219]
    ds_read_b128 v[92:95], v10 offset:18432
    v_mfma_f32_16x16x32_bf16 v[220:223], v[120:123], v[140:143], v[220:223]
    ds_read_b128 v[96:99], v10 offset:20480
    v_mfma_f32_16x16x32_bf16 v[252:255], v[124:127], v[140:143], v[252:255]
    ds_read_b128 v[100:103], v10 offset:22528
    s_waitcnt lgkmcnt(13)
    v_mfma_f32_16x16x32_bf16 v[160:163], v[64:67], v[88:91], v[160:163]
    s_add_u32 s36, s36, 98304
    s_add_u32 m0, s38, 49152
    s_waitcnt lgkmcnt(11)
    v_mfma_f32_16x16x32_bf16 v[164:167], v[68:71], v[88:91], v[164:167]
    buffer_load_dwordx4 v8, s[12:15], s36 offen lds
    s_waitcnt lgkmcnt(9)
    v_mfma_f32_16x16x32_bf16 v[224:227], v[72:75], v[88:91], v[224:227]
    s_waitcnt lgkmcnt(7)
    v_mfma_f32_16x16x32_bf16 v[168:171], v[76:79], v[88:91], v[168:171]
    buffer_load_dwordx4 v9, s[12:15], s36 offen offset:1024 lds
    s_waitcnt lgkmcnt(5)
    v_mfma_f32_16x16x32_bf16 v[172:175], v[80:83], v[88:91], v[172:175]
    s_waitcnt lgkmcnt(3)
    v_mfma_f32_16x16x32_bf16 v[232:235], v[84:87], v[88:91], v[232:235]
    buffer_load_dwordx4 v7, s[12:15], s36 offen offset:2048 lds
    s_waitcnt lgkmcnt(2)
    v_mfma_f32_16x16x32_bf16 v[176:179], v[64:67], v[92:95], v[176:179]
    s_waitcnt lgkmcnt(0)
    v_mfma_f32_16x16x32_bf16 v[180:183], v[68:71], v[92:95], v[180:183]
    s_waitcnt vmcnt(10)
    s_barrier
    v_mfma_f32_16x16x32_bf16 v[228:231], v[72:75], v[92:95], v[228:231]
    ds_read_b128 v[128:131], v11 offset:16384
    v_mfma_f32_16x16x32_bf16 v[184:187], v[76:79], v[92:95], v[184:187]
    ds_read_b64_tr_b16 v[104:105], v14 offset:36864
    v_mfma_f32_16x16x32_bf16 v[188:191], v[80:83], v[92:95], v[188:191]
    ds_read_b64_tr_b16 v[106:107], v14 offset:37632
    v_mfma_f32_16x16x32_bf16 v[236:239], v[84:87], v[92:95], v[236:239]
    ds_read_b64_tr_b16 v[108:109], v15 offset:36864
    v_mfma_f32_16x16x32_bf16 v[192:195], v[64:67], v[96:99], v[192:195]
    ds_read_b64_tr_b16 v[110:111], v15 offset:37632
    s_add_u32 m0, s37, 2048
    v_mfma_f32_16x16x32_bf16 v[196:199], v[68:71], v[96:99], v[196:199]
    buffer_load_dwordx4 v4, s[8:11], s63 offen  lds
    ds_read_b64_tr_b16 v[112:113], v16 offset:36864
    v_mfma_f32_16x16x32_bf16 v[240:243], v[72:75], v[96:99], v[240:243]
    ds_read_b64_tr_b16 v[114:115], v16 offset:37632
    v_mfma_f32_16x16x32_bf16 v[200:203], v[76:79], v[96:99], v[200:203]
    ds_read_b64_tr_b16 v[116:117], v14 offset:43008
    v_mfma_f32_16x16x32_bf16 v[204:207], v[80:83], v[96:99], v[204:207]
    buffer_load_dwordx4 v5, s[8:11], s63 offen offset:1024  lds
    ds_read_b64_tr_b16 v[118:119], v14 offset:43776
    v_mfma_f32_16x16x32_bf16 v[248:251], v[84:87], v[96:99], v[248:251]
    ds_read_b64_tr_b16 v[120:121], v15 offset:43008
    v_mfma_f32_16x16x32_bf16 v[208:211], v[64:67], v[100:103], v[208:211]
    ds_read_b64_tr_b16 v[122:123], v15 offset:43776
    s_mul_i32 s36, s63, 1536
    s_add_u32 m0, s38, 61440
    v_mfma_f32_16x16x32_bf16 v[212:215], v[68:71], v[100:103], v[212:215]
    buffer_load_dwordx4 v8, s[12:15], s36 offen lds
    ds_read_b64_tr_b16 v[124:125], v16 offset:43008
    v_mfma_f32_16x16x32_bf16 v[244:247], v[72:75], v[100:103], v[244:247]
    ds_read_b64_tr_b16 v[126:127], v16 offset:43776
    v_mfma_f32_16x16x32_bf16 v[216:219], v[76:79], v[100:103], v[216:219]
    ds_read_b128 v[132:135], v11 offset:18432
    v_mfma_f32_16x16x32_bf16 v[220:223], v[80:83], v[100:103], v[220:223]
    ds_read_b128 v[136:139], v11 offset:20480
    v_mfma_f32_16x16x32_bf16 v[252:255], v[84:87], v[100:103], v[252:255]
    ds_read_b128 v[140:143], v11 offset:22528
    s_waitcnt lgkmcnt(13)
    v_mfma_f32_16x16x32_bf16 v[160:163], v[104:107], v[128:131], v[160:163]
    s_waitcnt lgkmcnt(11)
    v_mfma_f32_16x16x32_bf16 v[164:167], v[108:111], v[128:131], v[164:167]
    buffer_load_dwordx4 v9, s[12:15], s36 offen offset:1024 lds
    s_waitcnt lgkmcnt(9)
    v_mfma_f32_16x16x32_bf16 v[224:227], v[112:115], v[128:131], v[224:227]
    s_waitcnt lgkmcnt(7)
    v_mfma_f32_16x16x32_bf16 v[168:171], v[116:119], v[128:131], v[168:171]
    buffer_load_dwordx4 v7, s[12:15], s36 offen offset:2048 lds
    s_waitcnt lgkmcnt(5)
    v_mfma_f32_16x16x32_bf16 v[172:175], v[120:123], v[128:131], v[172:175]
    s_waitcnt lgkmcnt(3)
    v_mfma_f32_16x16x32_bf16 v[232:235], v[124:127], v[128:131], v[232:235]
    s_waitcnt lgkmcnt(2)
    v_mfma_f32_16x16x32_bf16 v[176:179], v[104:107], v[132:135], v[176:179]
    s_waitcnt lgkmcnt(0)
    v_mfma_f32_16x16x32_bf16 v[180:183], v[108:111], v[132:135], v[180:183]
    s_waitcnt vmcnt(10)
    s_barrier
    v_mfma_f32_16x16x32_bf16 v[228:231], v[112:115], v[132:135], v[228:231]
    ds_read_b128 v[88:91], v10 offset:32768
    v_mfma_f32_16x16x32_bf16 v[184:187], v[116:119], v[132:135], v[184:187]
    ds_read_b64_tr_b16 v[64:65], v14 offset:49152
    v_mfma_f32_16x16x32_bf16 v[188:191], v[120:123], v[132:135], v[188:191]
    ds_read_b64_tr_b16 v[66:67], v14 offset:49920
    v_mfma_f32_16x16x32_bf16 v[236:239], v[124:127], v[132:135], v[236:239]
    ds_read_b64_tr_b16 v[68:69], v15 offset:49152
    v_mfma_f32_16x16x32_bf16 v[192:195], v[104:107], v[136:139], v[192:195]
    ds_read_b64_tr_b16 v[70:71], v15 offset:49920
    s_add_u32 m0, s37, 16384
    v_mfma_f32_16x16x32_bf16 v[196:199], v[108:111], v[136:139], v[196:199]
    buffer_load_dwordx4 v2, s[8:11], s64 offen  lds
    ds_read_b64_tr_b16 v[72:73], v16 offset:49152
    v_mfma_f32_16x16x32_bf16 v[240:243], v[112:115], v[136:139], v[240:243]
    ds_read_b64_tr_b16 v[74:75], v16 offset:49920
    v_mfma_f32_16x16x32_bf16 v[200:203], v[116:119], v[136:139], v[200:203]
    ds_read_b64_tr_b16 v[76:77], v14 offset:55296
    v_mfma_f32_16x16x32_bf16 v[204:207], v[120:123], v[136:139], v[204:207]
    buffer_load_dwordx4 v3, s[8:11], s64 offen offset:1024  lds
    ds_read_b64_tr_b16 v[78:79], v14 offset:56064
    v_mfma_f32_16x16x32_bf16 v[248:251], v[124:127], v[136:139], v[248:251]
    ds_read_b64_tr_b16 v[80:81], v15 offset:55296
    v_mfma_f32_16x16x32_bf16 v[208:211], v[104:107], v[140:143], v[208:211]
    ds_read_b64_tr_b16 v[82:83], v15 offset:56064
    s_add_u32 s36, s36, 98304
    s_add_u32 m0, s38, 73728
    v_mfma_f32_16x16x32_bf16 v[212:215], v[108:111], v[140:143], v[212:215]
    buffer_load_dwordx4 v8, s[12:15], s36 offen lds
    ds_read_b64_tr_b16 v[84:85], v16 offset:55296
    v_mfma_f32_16x16x32_bf16 v[244:247], v[112:115], v[140:143], v[244:247]
    ds_read_b64_tr_b16 v[86:87], v16 offset:56064
    v_mfma_f32_16x16x32_bf16 v[216:219], v[116:119], v[140:143], v[216:219]
    ds_read_b128 v[92:95], v10 offset:34816
    v_mfma_f32_16x16x32_bf16 v[220:223], v[120:123], v[140:143], v[220:223]
    buffer_load_dwordx4 v9, s[12:15], s36 offen offset:1024 lds
    ds_read_b128 v[96:99], v10 offset:36864
    v_mfma_f32_16x16x32_bf16 v[252:255], v[124:127], v[140:143], v[252:255]
    ds_read_b128 v[100:103], v10 offset:38912
    s_waitcnt lgkmcnt(13)
    v_mfma_f32_16x16x32_bf16 v[160:163], v[64:67], v[88:91], v[160:163]
    s_waitcnt lgkmcnt(11)
    v_mfma_f32_16x16x32_bf16 v[164:167], v[68:71], v[88:91], v[164:167]
    buffer_load_dwordx4 v7, s[12:15], s36 offen offset:2048 lds
    s_waitcnt lgkmcnt(9)
    v_mfma_f32_16x16x32_bf16 v[224:227], v[72:75], v[88:91], v[224:227]
    s_add_u32 m0, s37, 18432
    s_waitcnt lgkmcnt(7)
    v_mfma_f32_16x16x32_bf16 v[168:171], v[76:79], v[88:91], v[168:171]
    buffer_load_dwordx4 v4, s[8:11], s64 offen  lds
    s_waitcnt lgkmcnt(5)
    v_mfma_f32_16x16x32_bf16 v[172:175], v[80:83], v[88:91], v[172:175]
    s_waitcnt lgkmcnt(3)
    v_mfma_f32_16x16x32_bf16 v[232:235], v[84:87], v[88:91], v[232:235]
    buffer_load_dwordx4 v5, s[8:11], s64 offen offset:1024  lds
    s_waitcnt lgkmcnt(2)
    v_mfma_f32_16x16x32_bf16 v[176:179], v[64:67], v[92:95], v[176:179]
    s_waitcnt lgkmcnt(0)
    v_mfma_f32_16x16x32_bf16 v[180:183], v[68:71], v[92:95], v[180:183]
    s_waitcnt vmcnt(12)
    s_barrier
    v_mfma_f32_16x16x32_bf16 v[228:231], v[72:75], v[92:95], v[228:231]
    ds_read_b128 v[128:131], v11 offset:32768
    v_mfma_f32_16x16x32_bf16 v[184:187], v[76:79], v[92:95], v[184:187]
    ds_read_b64_tr_b16 v[104:105], v14 offset:0
    v_mfma_f32_16x16x32_bf16 v[188:191], v[80:83], v[92:95], v[188:191]
    ds_read_b64_tr_b16 v[106:107], v14 offset:768
    v_mfma_f32_16x16x32_bf16 v[236:239], v[84:87], v[92:95], v[236:239]
    ds_read_b64_tr_b16 v[108:109], v15 offset:0
    v_mfma_f32_16x16x32_bf16 v[192:195], v[64:67], v[96:99], v[192:195]
    ds_read_b64_tr_b16 v[110:111], v15 offset:768
    s_mul_i32 s36, s64, 1536
    s_add_u32 m0, s38, 86016
    v_mfma_f32_16x16x32_bf16 v[196:199], v[68:71], v[96:99], v[196:199]
    buffer_load_dwordx4 v8, s[12:15], s36 offen lds
    ds_read_b64_tr_b16 v[112:113], v16 offset:0
    v_mfma_f32_16x16x32_bf16 v[240:243], v[72:75], v[96:99], v[240:243]
    ds_read_b64_tr_b16 v[114:115], v16 offset:768
    v_mfma_f32_16x16x32_bf16 v[200:203], v[76:79], v[96:99], v[200:203]
    ds_read_b64_tr_b16 v[116:117], v14 offset:6144
    v_mfma_f32_16x16x32_bf16 v[204:207], v[80:83], v[96:99], v[204:207]
    ds_read_b64_tr_b16 v[118:119], v14 offset:6912
    v_mfma_f32_16x16x32_bf16 v[248:251], v[84:87], v[96:99], v[248:251]
    ds_read_b64_tr_b16 v[120:121], v15 offset:6144
    v_mfma_f32_16x16x32_bf16 v[208:211], v[64:67], v[100:103], v[208:211]
    ds_read_b64_tr_b16 v[122:123], v15 offset:6912
    v_mfma_f32_16x16x32_bf16 v[212:215], v[68:71], v[100:103], v[212:215]
    buffer_load_dwordx4 v9, s[12:15], s36 offen offset:1024 lds
    ds_read_b64_tr_b16 v[124:125], v16 offset:6144
    v_mfma_f32_16x16x32_bf16 v[244:247], v[72:75], v[100:103], v[244:247]
    ds_read_b64_tr_b16 v[126:127], v16 offset:6912
    v_mfma_f32_16x16x32_bf16 v[216:219], v[76:79], v[100:103], v[216:219]
    ds_read_b128 v[132:135], v11 offset:34816
    v_mfma_f32_16x16x32_bf16 v[220:223], v[80:83], v[100:103], v[220:223]
    ds_read_b128 v[136:139], v11 offset:36864
    v_mfma_f32_16x16x32_bf16 v[252:255], v[84:87], v[100:103], v[252:255]
    ds_read_b128 v[140:143], v11 offset:38912
    s_waitcnt lgkmcnt(13)
    v_mfma_f32_16x16x32_bf16 v[160:163], v[104:107], v[128:131], v[160:163]
    s_waitcnt lgkmcnt(11)
    v_mfma_f32_16x16x32_bf16 v[164:167], v[108:111], v[128:131], v[164:167]
    buffer_load_dwordx4 v7, s[12:15], s36 offen offset:2048 lds
    v_mov_b32 v42, 0
    s_waitcnt lgkmcnt(9)
    v_mfma_f32_16x16x32_bf16 v[224:227], v[112:115], v[128:131], v[224:227]
    s_waitcnt lgkmcnt(7)
    v_mfma_f32_16x16x32_bf16 v[168:171], v[116:119], v[128:131], v[168:171]
    buffer_load_dwordx2 v[40:41], v42, s[28:31], 0 offen sc1
    s_waitcnt lgkmcnt(5)
    v_mfma_f32_16x16x32_bf16 v[172:175], v[120:123], v[128:131], v[172:175]
    s_waitcnt lgkmcnt(3)
    v_mfma_f32_16x16x32_bf16 v[232:235], v[124:127], v[128:131], v[232:235]
    s_waitcnt lgkmcnt(2)
    v_mfma_f32_16x16x32_bf16 v[176:179], v[104:107], v[132:135], v[176:179]
    s_waitcnt lgkmcnt(0)
    v_mfma_f32_16x16x32_bf16 v[180:183], v[108:111], v[132:135], v[180:183]
    s_waitcnt vmcnt(11)
    s_barrier
    v_mfma_f32_16x16x32_bf16 v[228:231], v[112:115], v[132:135], v[228:231]
    ds_read_b128 v[88:91], v10 offset:0
    v_mfma_f32_16x16x32_bf16 v[184:187], v[116:119], v[132:135], v[184:187]
    ds_read_b64_tr_b16 v[64:65], v14 offset:12288
    v_mfma_f32_16x16x32_bf16 v[188:191], v[120:123], v[132:135], v[188:191]
    ds_read_b64_tr_b16 v[66:67], v14 offset:13056
    v_mfma_f32_16x16x32_bf16 v[236:239], v[124:127], v[132:135], v[236:239]
    ds_read_b64_tr_b16 v[68:69], v15 offset:12288
    v_mfma_f32_16x16x32_bf16 v[192:195], v[104:107], v[136:139], v[192:195]
    ds_read_b64_tr_b16 v[70:71], v15 offset:13056
    s_add_u32 m0, s37, 32768
    v_mfma_f32_16x16x32_bf16 v[196:199], v[108:111], v[136:139], v[196:199]
    buffer_load_dwordx4 v2, s[8:11], s65 offen  lds
    ds_read_b64_tr_b16 v[72:73], v16 offset:12288
    v_mfma_f32_16x16x32_bf16 v[240:243], v[112:115], v[136:139], v[240:243]
    ds_read_b64_tr_b16 v[74:75], v16 offset:13056
    v_mfma_f32_16x16x32_bf16 v[200:203], v[116:119], v[136:139], v[200:203]
    ds_read_b64_tr_b16 v[76:77], v14 offset:18432
    v_mfma_f32_16x16x32_bf16 v[204:207], v[120:123], v[136:139], v[204:207]
    buffer_load_dwordx4 v3, s[8:11], s65 offen offset:1024  lds
    ds_read_b64_tr_b16 v[78:79], v14 offset:19200
    v_mfma_f32_16x16x32_bf16 v[248:251], v[124:127], v[136:139], v[248:251]
    ds_read_b64_tr_b16 v[80:81], v15 offset:18432
    v_mfma_f32_16x16x32_bf16 v[208:211], v[104:107], v[140:143], v[208:211]
    ds_read_b64_tr_b16 v[82:83], v15 offset:19200
    s_add_u32 s36, s36, 98304
    s_add_u32 m0, s38, 98304
    v_mfma_f32_16x16x32_bf16 v[212:215], v[108:111], v[140:143], v[212:215]
    buffer_load_dwordx4 v8, s[12:15], s36 offen lds
    ds_read_b64_tr_b16 v[84:85], v16 offset:18432
    v_mfma_f32_16x16x32_bf16 v[244:247], v[112:115], v[140:143], v[244:247]
    ds_read_b64_tr_b16 v[86:87], v16 offset:19200
    v_mfma_f32_16x16x32_bf16 v[216:219], v[116:119], v[140:143], v[216:219]
    ds_read_b128 v[92:95], v10 offset:2048
    v_mfma_f32_16x16x32_bf16 v[220:223], v[120:123], v[140:143], v[220:223]
    buffer_load_dwordx4 v9, s[12:15], s36 offen offset:1024 lds
    ds_read_b128 v[96:99], v10 offset:4096
    v_mfma_f32_16x16x32_bf16 v[252:255], v[124:127], v[140:143], v[252:255]
    ds_read_b128 v[100:103], v10 offset:6144
    s_waitcnt lgkmcnt(13)
    v_mfma_f32_16x16x32_bf16 v[160:163], v[64:67], v[88:91], v[160:163]
    s_waitcnt lgkmcnt(11)
    v_mfma_f32_16x16x32_bf16 v[164:167], v[68:71], v[88:91], v[164:167]
    buffer_load_dwordx4 v7, s[12:15], s36 offen offset:2048 lds
    s_waitcnt lgkmcnt(9)
    v_mfma_f32_16x16x32_bf16 v[224:227], v[72:75], v[88:91], v[224:227]
    s_add_u32 m0, s37, 34816
    s_waitcnt lgkmcnt(7)
    v_mfma_f32_16x16x32_bf16 v[168:171], v[76:79], v[88:91], v[168:171]
    buffer_load_dwordx4 v4, s[8:11], s65 offen  lds
    s_waitcnt lgkmcnt(5)
    v_mfma_f32_16x16x32_bf16 v[172:175], v[80:83], v[88:91], v[172:175]
    s_waitcnt lgkmcnt(3)
    v_mfma_f32_16x16x32_bf16 v[232:235], v[84:87], v[88:91], v[232:235]
    buffer_load_dwordx4 v5, s[8:11], s65 offen offset:1024  lds
    s_waitcnt lgkmcnt(2)
    v_mfma_f32_16x16x32_bf16 v[176:179], v[64:67], v[92:95], v[176:179]
    s_waitcnt lgkmcnt(0)
    v_mfma_f32_16x16x32_bf16 v[180:183], v[68:71], v[92:95], v[180:183]
    s_waitcnt vmcnt(13)
    s_barrier
    v_mfma_f32_16x16x32_bf16 v[228:231], v[72:75], v[92:95], v[228:231]
    ds_read_b128 v[128:131], v11 offset:0
    v_mfma_f32_16x16x32_bf16 v[184:187], v[76:79], v[92:95], v[184:187]
    ds_read_b64_tr_b16 v[104:105], v14 offset:24576
    v_mfma_f32_16x16x32_bf16 v[188:191], v[80:83], v[92:95], v[188:191]
    ds_read_b64_tr_b16 v[106:107], v14 offset:25344
    v_mfma_f32_16x16x32_bf16 v[236:239], v[84:87], v[92:95], v[236:239]
    ds_read_b64_tr_b16 v[108:109], v15 offset:24576
    v_mfma_f32_16x16x32_bf16 v[192:195], v[64:67], v[96:99], v[192:195]
    ds_read_b64_tr_b16 v[110:111], v15 offset:25344
    s_mul_i32 s36, s65, 1536
    s_add_u32 m0, s38, 49152
    v_mfma_f32_16x16x32_bf16 v[196:199], v[68:71], v[96:99], v[196:199]
    buffer_load_dwordx4 v8, s[12:15], s36 offen lds
    ds_read_b64_tr_b16 v[112:113], v16 offset:24576
    v_mfma_f32_16x16x32_bf16 v[240:243], v[72:75], v[96:99], v[240:243]
    ds_read_b64_tr_b16 v[114:115], v16 offset:25344
    v_mfma_f32_16x16x32_bf16 v[200:203], v[76:79], v[96:99], v[200:203]
    ds_read_b64_tr_b16 v[116:117], v14 offset:30720
    v_mfma_f32_16x16x32_bf16 v[204:207], v[80:83], v[96:99], v[204:207]
    ds_read_b64_tr_b16 v[118:119], v14 offset:31488
    v_mfma_f32_16x16x32_bf16 v[248:251], v[84:87], v[96:99], v[248:251]
    ds_read_b64_tr_b16 v[120:121], v15 offset:30720
    v_mfma_f32_16x16x32_bf16 v[208:211], v[64:67], v[100:103], v[208:211]
    ds_read_b64_tr_b16 v[122:123], v15 offset:31488
    v_mfma_f32_16x16x32_bf16 v[212:215], v[68:71], v[100:103], v[212:215]
    buffer_load_dwordx4 v9, s[12:15], s36 offen offset:1024 lds
    ds_read_b64_tr_b16 v[124:125], v16 offset:30720
    v_mfma_f32_16x16x32_bf16 v[244:247], v[72:75], v[100:103], v[244:247]
    ds_read_b64_tr_b16 v[126:127], v16 offset:31488
    v_mfma_f32_16x16x32_bf16 v[216:219], v[76:79], v[100:103], v[216:219]
    ds_read_b128 v[132:135], v11 offset:2048
    v_mfma_f32_16x16x32_bf16 v[220:223], v[80:83], v[100:103], v[220:223]
    ds_read_b128 v[136:139], v11 offset:4096
    v_mfma_f32_16x16x32_bf16 v[252:255], v[84:87], v[100:103], v[252:255]
    ds_read_b128 v[140:143], v11 offset:6144
    s_waitcnt lgkmcnt(13)
    v_mfma_f32_16x16x32_bf16 v[160:163], v[104:107], v[128:131], v[160:163]
    s_waitcnt lgkmcnt(11)
    v_mfma_f32_16x16x32_bf16 v[164:167], v[108:111], v[128:131], v[164:167]
    buffer_load_dwordx4 v7, s[12:15], s36 offen offset:2048 lds
    s_waitcnt lgkmcnt(9)
    v_mfma_f32_16x16x32_bf16 v[224:227], v[112:115], v[128:131], v[224:227]
    s_waitcnt lgkmcnt(7)
    v_mfma_f32_16x16x32_bf16 v[168:171], v[116:119], v[128:131], v[168:171]
    s_waitcnt lgkmcnt(5)
    v_mfma_f32_16x16x32_bf16 v[172:175], v[120:123], v[128:131], v[172:175]
    s_waitcnt lgkmcnt(3)
    v_mfma_f32_16x16x32_bf16 v[232:235], v[124:127], v[128:131], v[232:235]
    s_waitcnt lgkmcnt(2)
    v_mfma_f32_16x16x32_bf16 v[176:179], v[104:107], v[132:135], v[176:179]
    s_waitcnt lgkmcnt(0)
    v_mfma_f32_16x16x32_bf16 v[180:183], v[108:111], v[132:135], v[180:183]
    s_waitcnt vmcnt(11)
    s_barrier
    v_mfma_f32_16x16x32_bf16 v[228:231], v[112:115], v[132:135], v[228:231]
    ds_read_b128 v[88:91], v10 offset:16384
    v_mfma_f32_16x16x32_bf16 v[184:187], v[116:119], v[132:135], v[184:187]
    ds_read_b64_tr_b16 v[64:65], v14 offset:36864
    v_mfma_f32_16x16x32_bf16 v[188:191], v[120:123], v[132:135], v[188:191]
    ds_read_b64_tr_b16 v[66:67], v14 offset:37632
    v_mfma_f32_16x16x32_bf16 v[236:239], v[124:127], v[132:135], v[236:239]
    ds_read_b64_tr_b16 v[68:69], v15 offset:36864
    v_mfma_f32_16x16x32_bf16 v[192:195], v[104:107], v[136:139], v[192:195]
    ds_read_b64_tr_b16 v[70:71], v15 offset:37632
    s_add_u32 m0, s37, 0
    v_mfma_f32_16x16x32_bf16 v[196:199], v[108:111], v[136:139], v[196:199]
    buffer_load_dwordx4 v2, s[8:11], s66 offen  lds
    ds_read_b64_tr_b16 v[72:73], v16 offset:36864
    v_mfma_f32_16x16x32_bf16 v[240:243], v[112:115], v[136:139], v[240:243]
    ds_read_b64_tr_b16 v[74:75], v16 offset:37632
    v_mfma_f32_16x16x32_bf16 v[200:203], v[116:119], v[136:139], v[200:203]
    ds_read_b64_tr_b16 v[76:77], v14 offset:43008
    v_mfma_f32_16x16x32_bf16 v[204:207], v[120:123], v[136:139], v[204:207]
    buffer_load_dwordx4 v3, s[8:11], s66 offen offset:1024  lds
    ds_read_b64_tr_b16 v[78:79], v14 offset:43776
    v_mfma_f32_16x16x32_bf16 v[248:251], v[124:127], v[136:139], v[248:251]
    ds_read_b64_tr_b16 v[80:81], v15 offset:43008
    v_mfma_f32_16x16x32_bf16 v[208:211], v[104:107], v[140:143], v[208:211]
    ds_read_b64_tr_b16 v[82:83], v15 offset:43776
    s_add_u32 s36, s36, 98304
    s_add_u32 m0, s38, 61440
    v_mfma_f32_16x16x32_bf16 v[212:215], v[108:111], v[140:143], v[212:215]
    buffer_load_dwordx4 v8, s[12:15], s36 offen lds
    ds_read_b64_tr_b16 v[84:85], v16 offset:43008
    v_mfma_f32_16x16x32_bf16 v[244:247], v[112:115], v[140:143], v[244:247]
    ds_read_b64_tr_b16 v[86:87], v16 offset:43776
    v_mfma_f32_16x16x32_bf16 v[216:219], v[116:119], v[140:143], v[216:219]
    ds_read_b128 v[92:95], v10 offset:18432
    v_mfma_f32_16x16x32_bf16 v[220:223], v[120:123], v[140:143], v[220:223]
    buffer_load_dwordx4 v9, s[12:15], s36 offen offset:1024 lds
    ds_read_b128 v[96:99], v10 offset:20480
    v_mfma_f32_16x16x32_bf16 v[252:255], v[124:127], v[140:143], v[252:255]
    ds_read_b128 v[100:103], v10 offset:22528
    s_waitcnt lgkmcnt(13)
    v_mfma_f32_16x16x32_bf16 v[160:163], v[64:67], v[88:91], v[160:163]
    s_waitcnt lgkmcnt(11)
    v_mfma_f32_16x16x32_bf16 v[164:167], v[68:71], v[88:91], v[164:167]
    buffer_load_dwordx4 v7, s[12:15], s36 offen offset:2048 lds
    s_waitcnt vmcnt(15)
    v_cmp_ne_u32 vcc, 0, v40
    s_nop 1
    s_cbranch_vccnz L_tag_okB
    s_mov_b32 s5, 60000
L_tag_spinB:
    s_sleep 2
    buffer_load_dwordx2 v[40:41], v42, s[28:31], 0 offen sc1
    s_waitcnt vmcnt(0)
    v_cmp_ne_u32 vcc, 0, v40
    s_nop 1
    s_cbranch_vccnz L_tag_okB
    s_sub_u32 s5, s5, 1
    s_cmp_lg_u32 s5, 0
    s_cbranch_scc1 L_tag_spinB
L_tag_okB:
    v_mov_b32 v42, v40
    v_mov_b32 v43, v41
    s_waitcnt lgkmcnt(9)
    v_mfma_f32_16x16x32_bf16 v[224:227], v[72:75], v[88:91], v[224:227]
    s_add_u32 m0, s37, 2048
    s_waitcnt lgkmcnt(7)
    v_mfma_f32_16x16x32_bf16 v[168:171], v[76:79], v[88:91], v[168:171]
    buffer_load_dwordx4 v4, s[8:11], s66 offen  lds
    s_waitcnt lgkmcnt(5)
    v_mfma_f32_16x16x32_bf16 v[172:175], v[80:83], v[88:91], v[172:175]
    s_waitcnt lgkmcnt(3)
    v_mfma_f32_16x16x32_bf16 v[232:235], v[84:87], v[88:91], v[232:235]
    buffer_load_dwordx4 v5, s[8:11], s66 offen offset:1024  lds
    s_waitcnt lgkmcnt(2)
    v_mfma_f32_16x16x32_bf16 v[176:179], v[64:67], v[92:95], v[176:179]
    s_waitcnt lgkmcnt(0)
    v_mfma_f32_16x16x32_bf16 v[180:183], v[68:71], v[92:95], v[180:183]
    s_waitcnt vmcnt(12)
    s_barrier
    v_mfma_f32_16x16x32_bf16 v[228:231], v[72:75], v[92:95], v[228:231]
    ds_read_b128 v[128:131], v11 offset:16384
    v_mfma_f32_16x16x32_bf16 v[184:187], v[76:79], v[92:95], v[184:187]
    ds_read_b64_tr_b16 v[104:105], v14 offset:49152
    v_mfma_f32_16x16x32_bf16 v[188:191], v[80:83], v[92:95], v[188:191]
    ds_read_b64_tr_b16 v[106:107], v14 offset:49920
    v_mfma_f32_16x16x32_bf16 v[236:239], v[84:87], v[92:95], v[236:239]
    ds_read_b64_tr_b16 v[108:109], v15 offset:49152
    v_mfma_f32_16x16x32_bf16 v[192:195], v[64:67], v[96:99], v[192:195]
    ds_read_b64_tr_b16 v[110:111], v15 offset:49920
    s_mul_i32 s36, s66, 1536
    s_add_u32 m0, s38, 73728
    v_mfma_f32_16x16x32_bf16 v[196:199], v[68:71], v[96:99], v[196:199]
    buffer_load_dwordx4 v8, s[12:15], s36 offen lds
    ds_read_b64_tr_b16 v[112:113], v16 offset:49152
    v_mfma_f32_16x16x32_bf16 v[240:243], v[72:75], v[96:99], v[240:243]
    ds_read_b64_tr_b16 v[114:115], v16 offset:49920
    v_mfma_f32_16x16x32_bf16 v[200:203], v[76:79], v[96:99], v[200:203]
    ds_read_b64_tr_b16 v[116:117], v14 offset:55296
    v_mfma_f32_16x16x32_bf16 v[204:207], v[80:83], v[96:99], v[204:207]
    ds_read_b64_tr_b16 v[118:119], v14 offset:56064
    v_mfma_f32_16x16x32_bf16 v[248:251], v[84:87], v[96:99], v[248:251]
    ds_read_b64_tr_b16 v[120:121], v15 offset:55296
    v_mfma_f32_16x16x32_bf16 v[208:211], v[64:67], v[100:103], v[208:211]
    ds_read_b64_tr_b16 v[122:123], v15 offset:56064
    v_mfma_f32_16x16x32_bf16 v[212:215], v[68:71], v[100:103], v[212:215]
    buffer_load_dwordx4 v9, s[12:15], s36 offen offset:1024 lds
    ds_read_b64_tr_b16 v[124:125], v16 offset:55296
    v_mfma_f32_16x16x32_bf16 v[244:247], v[72:75], v[100:103], v[244:247]
    ds_read_b64_tr_b16 v[126:127], v16 offset:56064
    v_mfma_f32_16x16x32_bf16 v[216:219], v[76:79], v[100:103], v[216:219]
    ds_read_b128 v[132:135], v11 offset:18432
    v_mfma_f32_16x16x32_bf16 v[220:223], v[80:83], v[100:103], v[220:223]
    ds_read_b128 v[136:139], v11 offset:20480
    v_mfma_f32_16x16x32_bf16 v[252:255], v[84:87], v[100:103], v[252:255]
    ds_read_b128 v[140:143], v11 offset:22528
    s_waitcnt lgkmcnt(13)
    v_mfma_f32_16x16x32_bf16 v[160:163], v[104:107], v[128:131], v[160:163]
    s_waitcnt lgkmcnt(11)
    v_mfma_f32_16x16x32_bf16 v[164:167], v[108:111], v[128:131], v[164:167]
    buffer_load_dwordx4 v7, s[12:15], s36 offen offset:2048 lds
    s_waitcnt lgkmcnt(9)
    v_mfma_f32_16x16x32_bf16 v[224:227], v[112:115], v[128:131], v[224:227]
    s_waitcnt lgkmcnt(7)
    v_mfma_f32_16x16x32_bf16 v[168:171], v[116:119], v[128:131], v[168:171]
    s_waitcnt lgkmcnt(5)
    v_mfma_f32_16x16x32_bf16 v[172:175], v[120:123], v[128:131], v[172:175]
    s_waitcnt lgkmcnt(3)
    v_mfma_f32_16x16x32_bf16 v[232:235], v[124:127], v[128:131], v[232:235]
    s_waitcnt lgkmcnt(2)
    v_mfma_f32_16x16x32_bf16 v[176:179], v[104:107], v[132:135], v[176:179]
    s_waitcnt lgkmcnt(0)
    v_mfma_f32_16x16x32_bf16 v[180:183], v[108:111], v[132:135], v[180:183]
    s_waitcnt vmcnt(10)
    s_barrier
    v_mfma_f32_16x16x32_bf16 v[228:231], v[112:115], v[132:135], v[228:231]
    ds_read_b128 v[88:91], v10 offset:32768
    v_mfma_f32_16x16x32_bf16 v[184:187], v[116:119], v[132:135], v[184:187]
    ds_read_b64_tr_b16 v[64:65], v14 offset:0
    v_mfma_f32_16x16x32_bf16 v[188:191], v[120:123], v[132:135], v[188:191]
    ds_read_b64_tr_b16 v[66:67], v14 offset:768
    v_mfma_f32_16x16x32_bf16 v[236:239], v[124:127], v[132:135], v[236:239]
    ds_read_b64_tr_b16 v[68:69], v15 offset:0
    v_mfma_f32_16x16x32_bf16 v[192:195], v[104:107], v[136:139], v[192:195]
    ds_read_b64_tr_b16 v[70:71], v15 offset:768
    s_add_u32 m0, s37, 16384
    v_mfma_f32_16x16x32_bf16 v[196:199], v[108:111], v[136:139], v[196:199]
    buffer_load_dwordx4 v2, s[8:11], s67 offen  lds
    ds_read_b64_tr_b16 v[72:73], v16 offset:0
    v_mfma_f32_16x16x32_bf16 v[240:243], v[112:115], v[136:139], v[240:243]
    ds_read_b64_tr_b16 v[74:75], v16 offset:768
    v_mfma_f32_16x16x32_bf16 v[200:203], v[116:119], v[136:139], v[200:203]
    ds_read_b64_tr_b16 v[76:77], v14 offset:6144
    v_mfma_f32_16x16x32_bf16 v[204:207], v[120:123], v[136:139], v[204:207]
    buffer_load_dwordx4 v3, s[8:11], s67 offen offset:1024  lds
    ds_read_b64_tr_b16 v[78:79], v14 offset:6912
    v_mfma_f32_16x16x32_bf16 v[248:251], v[124:127], v[136:139], v[248:251]
    ds_read_b64_tr_b16 v[80:81], v15 offset:6144
    v_mfma_f32_16x16x32_bf16 v[208:211], v[104:107], v[140:143], v[208:211]
    ds_read_b64_tr_b16 v[82:83], v15 offset:6912
    s_add_u32 s36, s36, 98304
    s_add_u32 m0, s38, 86016
    v_mfma_f32_16x16x32_bf16 v[212:215], v[108:111], v[140:143], v[212:215]
    buffer_load_dwordx4 v8, s[12:15], s36 offen lds
    ds_read_b64_tr_b16 v[84:85], v16 offset:6144
    v_mfma_f32_16x16x32_bf16 v[244:247], v[112:115], v[140:143], v[244:247]
    ds_read_b64_tr_b16 v[86:87], v16 offset:6912
    v_mfma_f32_16x16x32_bf16 v[216:219], v[116:119], v[140:143], v[216:219]
    ds_read_b128 v[92:95], v10 offset:34816
    v_mfma_f32_16x16x32_bf16 v[220:223], v[120:123], v[140:143], v[220:223]
    buffer_load_dwordx4 v9, s[12:15], s36 offen offset:1024 lds
    ds_read_b128 v[96:99], v10 offset:36864
    v_mfma_f32_16x16x32_bf16 v[252:255], v[124:127], v[140:143], v[252:255]
    ds_read_b128 v[100:103], v10 offset:38912
    s_waitcnt lgkmcnt(13)
    v_mfma_f32_16x16x32_bf16 v[160:163], v[64:67], v[88:91], v[160:163]
    s_waitcnt lgkmcnt(11)
    v_mfma_f32_16x16x32_bf16 v[164:167], v[68:71], v[88:91], v[164:167]
    buffer_load_dwordx4 v7, s[12:15], s36 offen offset:2048 lds
    s_waitcnt lgkmcnt(9)
    v_mfma_f32_16x16x32_bf16 v[224:227], v[72:75], v[88:91], v[224:227]
    s_add_u32 m0, s37, 18432
    s_waitcnt lgkmcnt(7)
    v_mfma_f32_16x16x32_bf16 v[168:171], v[76:79], v[88:91], v[168:171]
    buffer_load_dwordx4 v4, s[8:11], s67 offen  lds
    s_waitcnt lgkmcnt(5)
    v_mfma_f32_16x16x32_bf16 v[172:175], v[80:83], v[88:91], v[172:175]
    s_waitcnt lgkmcnt(3)
    v_mfma_f32_16x16x32_bf16 v[232:235], v[84:87], v[88:91], v[232:235]
    buffer_load_dwordx4 v5, s[8:11], s67 offen offset:1024  lds
    s_waitcnt lgkmcnt(2)
    v_mfma_f32_16x16x32_bf16 v[176:179], v[64:67], v[92:95], v[176:179]
    s_waitcnt lgkmcnt(0)
    v_mfma_f32_16x16x32_bf16 v[180:183], v[68:71], v[92:95], v[180:183]
    s_waitcnt vmcnt(12)
    s_barrier
    v_mfma_f32_16x16x32_bf16 v[228:231], v[72:75], v[92:95], v[228:231]
    ds_read_b128 v[128:131], v11 offset:32768
    v_mfma_f32_16x16x32_bf16 v[184:187], v[76:79], v[92:95], v[184:187]
    ds_read_b64_tr_b16 v[104:105], v14 offset:12288
    v_mfma_f32_16x16x32_bf16 v[188:191], v[80:83], v[92:95], v[188:191]
    ds_read_b64_tr_b16 v[106:107], v14 offset:13056
    v_mfma_f32_16x16x32_bf16 v[236:239], v[84:87], v[92:95], v[236:239]
    ds_read_b64_tr_b16 v[108:109], v15 offset:12288
    v_mfma_f32_16x16x32_bf16 v[192:195], v[64:67], v[96:99], v[192:195]
    ds_read_b64_tr_b16 v[110:111], v15 offset:13056
    s_mul_i32 s36, s67, 1536
    s_add_u32 m0, s38, 98304
    v_mfma_f32_16x16x32_bf16 v[196:199], v[68:71], v[96:99], v[196:199]
    buffer_load_dwordx4 v8, s[12:15], s36 offen lds
    ds_read_b64_tr_b16 v[112:113], v16 offset:12288
    v_mfma_f32_16x16x32_bf16 v[240:243], v[72:75], v[96:99], v[240:243]
    ds_read_b64_tr_b16 v[114:115], v16 offset:13056
    v_mfma_f32_16x16x32_bf16 v[200:203], v[76:79], v[96:99], v[200:203]
    ds_read_b64_tr_b16 v[116:117], v14 offset:18432
    v_mfma_f32_16x16x32_bf16 v[204:207], v[80:83], v[96:99], v[204:207]
    ds_read_b64_tr_b16 v[118:119], v14 offset:19200
    v_mfma_f32_16x16x32_bf16 v[248:251], v[84:87], v[96:99], v[248:251]
    ds_read_b64_tr_b16 v[120:121], v15 offset:18432
    v_mfma_f32_16x16x32_bf16 v[208:211], v[64:67], v[100:103], v[208:211]
    ds_read_b64_tr_b16 v[122:123], v15 offset:19200
    v_mfma_f32_16x16x32_bf16 v[212:215], v[68:71], v[100:103], v[212:215]
    buffer_load_dwordx4 v9, s[12:15], s36 offen offset:1024 lds
    ds_read_b64_tr_b16 v[124:125], v16 offset:18432
    v_mfma_f32_16x16x32_bf16 v[244:247], v[72:75], v[100:103], v[244:247]
    ds_read_b64_tr_b16 v[126:127], v16 offset:19200
    v_mfma_f32_16x16x32_bf16 v[216:219], v[76:79], v[100:103], v[216:219]
    ds_read_b128 v[132:135], v11 offset:34816
    v_mfma_f32_16x16x32_bf16 v[220:223], v[80:83], v[100:103], v[220:223]
    ds_read_b128 v[136:139], v11 offset:36864
    v_mfma_f32_16x16x32_bf16 v[252:255], v[84:87], v[100:103], v[252:255]
    ds_read_b128 v[140:143], v11 offset:38912
    s_waitcnt lgkmcnt(13)
    v_mfma_f32_16x16x32_bf16 v[160:163], v[104:107], v[128:131], v[160:163]
    s_waitcnt lgkmcnt(11)
    v_mfma_f32_16x16x32_bf16 v[164:167], v[108:111], v[128:131], v[164:167]
    buffer_load_dwordx4 v7, s[12:15], s36 offen offset:2048 lds
    s_waitcnt lgkmcnt(9)
    v_mfma_f32_16x16x32_bf16 v[224:227], v[112:115], v[128:131], v[224:227]
    s_waitcnt lgkmcnt(7)
    v_mfma_f32_16x16x32_bf16 v[168:171], v[116:119], v[128:131], v[168:171]
    s_waitcnt lgkmcnt(5)
    v_mfma_f32_16x16x32_bf16 v[172:175], v[120:123], v[128:131], v[172:175]
    s_waitcnt lgkmcnt(3)
    v_mfma_f32_16x16x32_bf16 v[232:235], v[124:127], v[128:131], v[232:235]
    s_waitcnt lgkmcnt(2)
    v_mfma_f32_16x16x32_bf16 v[176:179], v[104:107], v[132:135], v[176:179]
    s_waitcnt lgkmcnt(0)
    v_mfma_f32_16x16x32_bf16 v[180:183], v[108:111], v[132:135], v[180:183]
    s_waitcnt vmcnt(10)
    s_barrier
    v_mfma_f32_16x16x32_bf16 v[228:231], v[112:115], v[132:135], v[228:231]
    ds_read_b128 v[88:91], v10 offset:0
    v_mfma_f32_16x16x32_bf16 v[184:187], v[116:119], v[132:135], v[184:187]
    ds_read_b64_tr_b16 v[64:65], v14 offset:24576
    v_mfma_f32_16x16x32_bf16 v[188:191], v[120:123], v[132:135], v[188:191]
    ds_read_b64_tr_b16 v[66:67], v14 offset:25344
    v_mfma_f32_16x16x32_bf16 v[236:239], v[124:127], v[132:135], v[236:239]
    ds_read_b64_tr_b16 v[68:69], v15 offset:24576
    v_mfma_f32_16x16x32_bf16 v[192:195], v[104:107], v[136:139], v[192:195]
    ds_read_b64_tr_b16 v[70:71], v15 offset:25344
    s_add_u32 m0, s37, 32768
    v_mfma_f32_16x16x32_bf16 v[196:199], v[108:111], v[136:139], v[196:199]
    buffer_load_dwordx4 v2, s[8:11], s68 offen  lds
    ds_read_b64_tr_b16 v[72:73], v16 offset:24576
    v_mfma_f32_16x16x32_bf16 v[240:243], v[112:115], v[136:139], v[240:243]
    ds_read_b64_tr_b16 v[74:75], v16 offset:25344
    v_mfma_f32_16x16x32_bf16 v[200:203], v[116:119], v[136:139], v[200:203]
    ds_read_b64_tr_b16 v[76:77], v14 offset:30720
    v_mfma_f32_16x16x32_bf16 v[204:207], v[120:123], v[136:139], v[204:207]
    buffer_load_dwordx4 v3, s[8:11], s68 offen offset:1024  lds
    ds_read_b64_tr_b16 v[78:79], v14 offset:31488
    v_mfma_f32_16x16x32_bf16 v[248:251], v[124:127], v[136:139], v[248:251]
    ds_read_b64_tr_b16 v[80:81], v15 offset:30720
    v_mfma_f32_16x16x32_bf16 v[208:211], v[104:107], v[140:143], v[208:211]
    ds_read_b64_tr_b16 v[82:83], v15 offset:31488
    s_add_u32 s36, s36, 98304
    s_add_u32 m0, s38, 49152
    v_mfma_f32_16x16x32_bf16 v[212:215], v[108:111], v[140:143], v[212:215]
    buffer_load_dwordx4 v8, s[12:15], s36 offen lds
    ds_read_b64_tr_b16 v[84:85], v16 offset:30720
    v_mfma_f32_16x16x32_bf16 v[244:247], v[112:115], v[140:143], v[244:247]
    ds_read_b64_tr_b16 v[86:87], v16 offset:31488
    v_mfma_f32_16x16x32_bf16 v[216:219], v[116:119], v[140:143], v[216:219]
    ds_read_b128 v[92:95], v10 offset:2048
    v_mfma_f32_16x16x32_bf16 v[220:223], v[120:123], v[140:143], v[220:223]
    buffer_load_dwordx4 v9, s[12:15], s36 offen offset:1024 lds
    ds_read_b128 v[96:99], v10 offset:4096
    v_mfma_f32_16x16x32_bf16 v[252:255], v[124:127], v[140:143], v[252:255]
    ds_read_b128 v[100:103], v10 offset:6144
    s_waitcnt lgkmcnt(13)
    v_mfma_f32_16x16x32_bf16 v[160:163], v[64:67], v[88:91], v[160:163]
    s_waitcnt lgkmcnt(11)
    v_mfma_f32_16x16x32_bf16 v[164:167], v[68:71], v[88:91], v[164:167]
    buffer_load_dwordx4 v7, s[12:15], s36 offen offset:2048 lds
    s_waitcnt lgkmcnt(9)
    v_mfma_f32_16x16x32_bf16 v[224:227], v[72:75], v[88:91], v[224:227]
    s_add_u32 m0, s37, 34816
    s_waitcnt lgkmcnt(7)
    v_mfma_f32_16x16x32_bf16 v[168:171], v[76:79], v[88:91], v[168:171]
    buffer_load_dwordx4 v4, s[8:11], s68 offen  lds
    s_waitcnt lgkmcnt(5)
    v_mfma_f32_16x16x32_bf16 v[172:175], v[80:83], v[88:91], v[172:175]
    s_waitcnt lgkmcnt(3)
    v_mfma_f32_16x16x32_bf16 v[232:235], v[84:87], v[88:91], v[232:235]
    buffer_load_dwordx4 v5, s[8:11], s68 offen offset:1024  lds
    s_waitcnt lgkmcnt(2)
    v_mfma_f32_16x16x32_bf16 v[176:179], v[64:67], v[92:95], v[176:179]
    buffer_load_dwordx2 v[152:153], v37, s[20:23], 0 offen sc1
    s_waitcnt lgkmcnt(0)
    v_mfma_f32_16x16x32_bf16 v[180:183], v[68:71], v[92:95], v[180:183]
    s_waitcnt vmcnt(13)
    s_barrier
    v_mfma_f32_16x16x32_bf16 v[228:231], v[72:75], v[92:95], v[228:231]
    ds_read_b128 v[128:131], v11 offset:0
    v_mfma_f32_16x16x32_bf16 v[184:187], v[76:79], v[92:95], v[184:187]
    ds_read_b64_tr_b16 v[104:105], v14 offset:36864
    v_mfma_f32_16x16x32_bf16 v[188:191], v[80:83], v[92:95], v[188:191]
    ds_read_b64_tr_b16 v[106:107], v14 offset:37632
    v_mfma_f32_16x16x32_bf16 v[236:239], v[84:87], v[92:95], v[236:239]
    ds_read_b64_tr_b16 v[108:109], v15 offset:36864
    v_mfma_f32_16x16x32_bf16 v[192:195], v[64:67], v[96:99], v[192:195]
    ds_read_b64_tr_b16 v[110:111], v15 offset:37632
    s_mul_i32 s36, s68, 1536
    s_add_u32 m0, s38, 61440
    v_mfma_f32_16x16x32_bf16 v[196:199], v[68:71], v[96:99], v[196:199]
    buffer_load_dwordx4 v8, s[12:15], s36 offen lds
    ds_read_b64_tr_b16 v[112:113], v16 offset:36864
    v_mfma_f32_16x16x32_bf16 v[240:243], v[72:75], v[96:99], v[240:243]
    ds_read_b64_tr_b16 v[114:115], v16 offset:37632
    v_mfma_f32_16x16x32_bf16 v[200:203], v[76:79], v[96:99], v[200:203]
    ds_read_b64_tr_b16 v[116:117], v14 offset:43008
    v_mfma_f32_16x16x32_bf16 v[204:207], v[80:83], v[96:99], v[204:207]
    ds_read_b64_tr_b16 v[118:119], v14 offset:43776
    v_mfma_f32_16x16x32_bf16 v[248:251], v[84:87], v[96:99], v[248:251]
    ds_read_b64_tr_b16 v[120:121], v15 offset:43008
    v_mfma_f32_16x16x32_bf16 v[208:211], v[64:67], v[100:103], v[208:211]
    ds_read_b64_tr_b16 v[122:123], v15 offset:43776
    v_mfma_f32_16x16x32_bf16 v[212:215], v[68:71], v[100:103], v[212:215]
    buffer_load_dwordx4 v9, s[12:15], s36 offen offset:1024 lds
    ds_read_b64_tr_b16 v[124:125], v16 offset:43008
    v_mfma_f32_16x16x32_bf16 v[244:247], v[72:75], v[100:103], v[244:247]
    ds_read_b64_tr_b16 v[126:127], v16 offset:43776
    v_mfma_f32_16x16x32_bf16 v[216:219], v[76:79], v[100:103], v[216:219]
    ds_read_b128 v[132:135], v11 offset:2048
    v_mfma_f32_16x16x32_bf16 v[220:223], v[80:83], v[100:103], v[220:223]
    ds_read_b128 v[136:139], v11 offset:4096
    v_mfma_f32_16x16x32_bf16 v[252:255], v[84:87], v[100:103], v[252:255]
    ds_read_b128 v[140:143], v11 offset:6144
    s_waitcnt lgkmcnt(13)
    v_mfma_f32_16x16x32_bf16 v[160:163], v[104:107], v[128:131], v[160:163]
    s_waitcnt lgkmcnt(11)
    v_mfma_f32_16x16x32_bf16 v[164:167], v[108:111], v[128:131], v[164:167]
    buffer_load_dwordx4 v7, s[12:15], s36 offen offset:2048 lds
    s_waitcnt lgkmcnt(9)
    v_mfma_f32_16x16x32_bf16 v[224:227], v[112:115], v[128:131], v[224:227]
    s_waitcnt lgkmcnt(7)
    v_mfma_f32_16x16x32_bf16 v[168:171], v[116:119], v[128:131], v[168:171]
    s_waitcnt lgkmcnt(5)
    v_mfma_f32_16x16x32_bf16 v[172:175], v[120:123], v[128:131], v[172:175]
    s_waitcnt lgkmcnt(3)
    v_mfma_f32_16x16x32_bf16 v[232:235], v[124:127], v[128:131], v[232:235]
    s_waitcnt lgkmcnt(2)
    v_mfma_f32_16x16x32_bf16 v[176:179], v[104:107], v[132:135], v[176:179]
    s_waitcnt lgkmcnt(0)
    v_mfma_f32_16x16x32_bf16 v[180:183], v[108:111], v[132:135], v[180:183]
    s_waitcnt vmcnt(11)
    s_barrier
    v_mfma_f32_16x16x32_bf16 v[228:231], v[112:115], v[132:135], v[228:231]
    ds_read_b128 v[88:91], v10 offset:16384
    v_mfma_f32_16x16x32_bf16 v[184:187], v[116:119], v[132:135], v[184:187]
    ds_read_b64_tr_b16 v[64:65], v14 offset:49152
    v_mfma_f32_16x16x32_bf16 v[188:191], v[120:123], v[132:135], v[188:191]
    ds_read_b64_tr_b16 v[66:67], v14 offset:49920
    v_mfma_f32_16x16x32_bf16 v[236:239], v[124:127], v[132:135], v[236:239]
    ds_read_b64_tr_b16 v[68:69], v15 offset:49152
    v_mfma_f32_16x16x32_bf16 v[192:195], v[104:107], v[136:139], v[192:195]
    ds_read_b64_tr_b16 v[70:71], v15 offset:49920
    s_add_u32 m0, s37, 0
    v_mfma_f32_16x16x32_bf16 v[196:199], v[108:111], v[136:139], v[196:199]
    buffer_load_dwordx4 v2, s[8:11], s69 offen  lds
    ds_read_b64_tr_b16 v[72:73], v16 offset:49152
    v_mfma_f32_16x16x32_bf16 v[240:243], v[112:115], v[136:139], v[240:243]
    ds_read_b64_tr_b16 v[74:75], v16 offset:49920
    v_mfma_f32_16x16x32_bf16 v[200:203], v[116:119], v[136:139], v[200:203]
    ds_read_b64_tr_b16 v[76:77], v14 offset:55296
    v_mfma_f32_16x16x32_bf16 v[204:207], v[120:123], v[136:139], v[204:207]
    buffer_load_dwordx4 v3, s[8:11], s69 offen offset:1024  lds
    ds_read_b64_tr_b16 v[78:79], v14 offset:56064
    v_mfma_f32_16x16x32_bf16 v[248:251], v[124:127], v[136:139], v[248:251]
    ds_read_b64_tr_b16 v[80:81], v15 offset:55296
    v_mfma_f32_16x16x32_bf16 v[208:211], v[104:107], v[140:143], v[208:211]
    ds_read_b64_tr_b16 v[82:83], v15 offset:56064
    s_add_u32 s36, s36, 98304
    s_add_u32 m0, s38, 73728
    v_mfma_f32_16x16x32_bf16 v[212:215], v[108:111], v[140:143], v[212:215]
    buffer_load_dwordx4 v8, s[12:15], s36 offen lds
    ds_read_b64_tr_b16 v[84:85], v16 offset:55296
    v_mfma_f32_16x16x32_bf16 v[244:247], v[112:115], v[140:143], v[244:247]
    ds_read_b64_tr_b16 v[86:87], v16 offset:56064
    v_mfma_f32_16x16x32_bf16 v[216:219], v[116:119], v[140:143], v[216:219]
    ds_read_b128 v[92:95], v10 offset:18432
    v_mfma_f32_16x16x32_bf16 v[220:223], v[120:123], v[140:143], v[220:223]
    buffer_load_dwordx4 v9, s[12:15], s36 offen offset:1024 lds
    ds_read_b128 v[96:99], v10 offset:20480
    v_mfma_f32_16x16x32_bf16 v[252:255], v[124:127], v[140:143], v[252:255]
    ds_read_b128 v[100:103], v10 offset:22528
    s_waitcnt lgkmcnt(13)
    v_mfma_f32_16x16x32_bf16 v[160:163], v[64:67], v[88:91], v[160:163]
    s_waitcnt lgkmcnt(11)
    v_mfma_f32_16x16x32_bf16 v[164:167], v[68:71], v[88:91], v[164:167]
    buffer_load_dwordx4 v7, s[12:15], s36 offen offset:2048 lds
    s_waitcnt lgkmcnt(9)
    v_mfma_f32_16x16x32_bf16 v[224:227], v[72:75], v[88:91], v[224:227]
    s_add_u32 m0, s37, 2048
    s_waitcnt lgkmcnt(7)
    v_mfma_f32_16x16x32_bf16 v[168:171], v[76:79], v[88:91], v[168:171]
    buffer_load_dwordx4 v4, s[8:11], s69 offen  lds
    s_waitcnt lgkmcnt(5)
    v_mfma_f32_16x16x32_bf16 v[172:175], v[80:83], v[88:91], v[172:175]
    s_waitcnt lgkmcnt(3)
    v_mfma_f32_16x16x32_bf16 v[232:235], v[84:87], v[88:91], v[232:235]
    buffer_load_dwordx4 v5, s[8:11], s69 offen offset:1024  lds
    s_waitcnt lgkmcnt(2)
    v_mfma_f32_16x16x32_bf16 v[176:179], v[64:67], v[92:95], v[176:179]
    s_waitcnt vmcnt(10)
    v_cmp_ne_u64 vcc, v[152:153], v[40:41]
    s_nop 1
    s_cbranch_vccz L_zfB_ok
    s_mov_b32 s5, 60000
L_zfB_spin:
    s_sleep 1
    buffer_load_dwordx2 v[152:153], v37, s[20:23], 0 offen sc1
    s_waitcnt vmcnt(0)
    v_cmp_ne_u64 vcc, v[152:153], v[40:41]
    s_nop 1
    s_cbranch_vccz L_zfB_ok
    s_sub_u32 s5, s5, 1
    s_cmp_lg_u32 s5, 0
    s_cbranch_scc1 L_zfB_spin
L_zfB_ok:
    s_waitcnt lgkmcnt(0)
    v_mfma_f32_16x16x32_bf16 v[180:183], v[68:71], v[92:95], v[180:183]
    s_barrier
    v_mfma_f32_16x16x32_bf16 v[228:231], v[72:75], v[92:95], v[228:231]
    ds_read_b128 v[128:131], v11 offset:16384
    v_mfma_f32_16x16x32_bf16 v[184:187], v[76:79], v[92:95], v[184:187]
    ds_read_b64_tr_b16 v[104:105], v14 offset:0
    v_mfma_f32_16x16x32_bf16 v[188:191], v[80:83], v[92:95], v[188:191]
    ds_read_b64_tr_b16 v[106:107], v14 offset:768
    v_mfma_f32_16x16x32_bf16 v[236:239], v[84:87], v[92:95], v[236:239]
    ds_read_b64_tr_b16 v[108:109], v15 offset:0
    v_mfma_f32_16x16x32_bf16 v[192:195], v[64:67], v[96:99], v[192:195]
    ds_read_b64_tr_b16 v[110:111], v15 offset:768
    s_mul_i32 s36, s69, 1536
    s_add_u32 m0, s38, 86016
    v_mfma_f32_16x16x32_bf16 v[196:199], v[68:71], v[96:99], v[196:199]
    buffer_load_dwordx4 v8, s[12:15], s36 offen lds
    ds_read_b64_tr_b16 v[112:113], v16 offset:0
    v_mfma_f32_16x16x32_bf16 v[240:243], v[72:75], v[96:99], v[240:243]
    ds_read_b64_tr_b16 v[114:115], v16 offset:768
    v_mfma_f32_16x16x32_bf16 v[200:203], v[76:79], v[96:99], v[200:203]
    ds_read_b64_tr_b16 v[116:117], v14 offset:6144
    v_mfma_f32_16x16x32_bf16 v[204:207], v[80:83], v[96:99], v[204:207]
    ds_read_b64_tr_b16 v[118:119], v14 offset:6912
    v_mfma_f32_16x16x32_bf16 v[248:251], v[84:87], v[96:99], v[248:251]
    ds_read_b64_tr_b16 v[120:121], v15 offset:6144
    v_mfma_f32_16x16x32_bf16 v[208:211], v[64:67], v[100:103], v[208:211]
    ds_read_b64_tr_b16 v[122:123], v15 offset:6912
    v_mfma_f32_16x16x32_bf16 v[212:215], v[68:71], v[100:103], v[212:215]
    buffer_load_dwordx4 v9, s[12:15], s36 offen offset:1024 lds
    ds_read_b64_tr_b16 v[124:125], v16 offset:6144
    v_mfma_f32_16x16x32_bf16 v[244:247], v[72:75], v[100:103], v[244:247]
    ds_read_b64_tr_b16 v[126:127], v16 offset:6912
    v_mfma_f32_16x16x32_bf16 v[216:219], v[76:79], v[100:103], v[216:219]
    ds_read_b128 v[132:135], v11 offset:18432
    v_mfma_f32_16x16x32_bf16 v[220:223], v[80:83], v[100:103], v[220:223]
    ds_read_b128 v[136:139], v11 offset:20480
    v_mfma_f32_16x16x32_bf16 v[252:255], v[84:87], v[100:103], v[252:255]
    ds_read_b128 v[140:143], v11 offset:22528
    s_waitcnt lgkmcnt(13)
    v_mfma_f32_16x16x32_bf16 v[160:163], v[104:107], v[128:131], v[160:163]
    s_waitcnt lgkmcnt(11)
    v_mfma_f32_16x16x32_bf16 v[164:167], v[108:111], v[128:131], v[164:167]
    buffer_load_dwordx4 v7, s[12:15], s36 offen offset:2048 lds
    s_waitcnt lgkmcnt(9)
    v_mfma_f32_16x16x32_bf16 v[224:227], v[112:115], v[128:131], v[224:227]
    s_add_u32 s36, s36, 98304
    s_add_u32 m0, s38, 98304
    s_waitcnt lgkmcnt(7)
    v_mfma_f32_16x16x32_bf16 v[168:171], v[116:119], v[128:131], v[168:171]
    buffer_load_dwordx4 v8, s[12:15], s36 offen lds
    s_waitcnt lgkmcnt(5)
    v_mfma_f32_16x16x32_bf16 v[172:175], v[120:123], v[128:131], v[172:175]
    s_waitcnt lgkmcnt(3)
    v_mfma_f32_16x16x32_bf16 v[232:235], v[124:127], v[128:131], v[232:235]
    buffer_load_dwordx4 v9, s[12:15], s36 offen offset:1024 lds
    s_waitcnt lgkmcnt(2)
    v_mfma_f32_16x16x32_bf16 v[176:179], v[104:107], v[132:135], v[176:179]
    s_waitcnt lgkmcnt(0)
    v_mfma_f32_16x16x32_bf16 v[180:183], v[108:111], v[132:135], v[180:183]
    s_waitcnt vmcnt(12)
    s_barrier
    v_mfma_f32_16x16x32_bf16 v[228:231], v[112:115], v[132:135], v[228:231]
    ds_read_b128 v[88:91], v10 offset:32768
    v_mfma_f32_16x16x32_bf16 v[184:187], v[116:119], v[132:135], v[184:187]
    ds_read_b64_tr_b16 v[64:65], v14 offset:12288
    v_mfma_f32_16x16x32_bf16 v[188:191], v[120:123], v[132:135], v[188:191]
    ds_read_b64_tr_b16 v[66:67], v14 offset:13056
    v_mfma_f32_16x16x32_bf16 v[236:239], v[124:127], v[132:135], v[236:239]
    ds_read_b64_tr_b16 v[68:69], v15 offset:12288
    v_mfma_f32_16x16x32_bf16 v[192:195], v[104:107], v[136:139], v[192:195]
    ds_read_b64_tr_b16 v[70:71], v15 offset:13056
    v_mfma_f32_16x16x32_bf16 v[196:199], v[108:111], v[136:139], v[196:199]
    buffer_load_dwordx4 v7, s[12:15], s36 offen offset:2048 lds
    ds_read_b64_tr_b16 v[72:73], v16 offset:12288
    v_mfma_f32_16x16x32_bf16 v[240:243], v[112:115], v[136:139], v[240:243]
    ds_read_b64_tr_b16 v[74:75], v16 offset:13056
    v_mfma_f32_16x16x32_bf16 v[200:203], v[116:119], v[136:139], v[200:203]
    ds_read_b64_tr_b16 v[76:77], v14 offset:18432
    v_mfma_f32_16x16x32_bf16 v[204:207], v[120:123], v[136:139], v[204:207]
    ds_read_b64_tr_b16 v[78:79], v14 offset:19200
    v_mfma_f32_16x16x32_bf16 v[248:251], v[124:127], v[136:139], v[248:251]
    ds_read_b64_tr_b16 v[80:81], v15 offset:18432
    v_mfma_f32_16x16x32_bf16 v[208:211], v[104:107], v[140:143], v[208:211]
    ds_read_b64_tr_b16 v[82:83], v15 offset:19200
    v_mfma_f32_16x16x32_bf16 v[212:215], v[108:111], v[140:143], v[212:215]
    buffer_load_dwordx4 a[0:3], v20, s[20:23], s39 offen sc1
    ds_read_b64_tr_b16 v[84:85], v16 offset:18432
    v_mfma_f32_16x16x32_bf16 v[244:247], v[112:115], v[140:143], v[244:247]
    ds_read_b64_tr_b16 v[86:87], v16 offset:19200
    v_mfma_f32_16x16x32_bf16 v[216:219], v[116:119], v[140:143], v[216:219]
    ds_read_b128 v[92:95], v10 offset:34816
    v_mfma_f32_16x16x32_bf16 v[220:223], v[120:123], v[140:143], v[220:223]
    ds_read_b128 v[96:99], v10 offset:36864
    v_mfma_f32_16x16x32_bf16 v[252:255], v[124:127], v[140:143], v[252:255]
    ds_read_b128 v[100:103], v10 offset:38912
    s_waitcnt lgkmcnt(13)
    v_mfma_f32_16x16x32_bf16 v[160:163], v[64:67], v[88:91], v[160:163]
    s_waitcnt lgkmcnt(11)
    v_mfma_f32_16x16x32_bf16 v[164:167], v[68:71], v[88:91], v[164:167]
    buffer_load_dwordx4 a[4:7], v20, s[20:23], s39 offen offset:1024 sc1
    s_waitcnt lgkmcnt(9)
    v_mfma_f32_16x16x32_bf16 v[224:227], v[72:75], v[88:91], v[224:227]
    s_waitcnt lgkmcnt(7)
    v_mfma_f32_16x16x32_bf16 v[168:171], v[76:79], v[88:91], v[168:171]
    buffer_load_dwordx4 a[8:11], v20, s[20:23], s39 offen offset:2048 sc1
    s_waitcnt lgkmcnt(5)
    v_mfma_f32_16x16x32_bf16 v[172:175], v[80:83], v[88:91], v[172:175]
    s_waitcnt lgkmcnt(3)
    v_mfma_f32_16x16x32_bf16 v[232:235], v[84:87], v[88:91], v[232:235]
    buffer_load_dwordx4 a[12:15], v20, s[20:23], s39 offen offset:3072 sc1
    s_waitcnt lgkmcnt(2)
    v_mfma_f32_16x16x32_bf16 v[176:179], v[64:67], v[92:95], v[176:179]
    s_waitcnt lgkmcnt(0)
    v_mfma_f32_16x16x32_bf16 v[180:183], v[68:71], v[92:95], v[180:183]
    s_waitcnt vmcnt(12)
    s_barrier
    v_mfma_f32_16x16x32_bf16 v[228:231], v[72:75], v[92:95], v[228:231]
    ds_read_b128 v[128:131], v11 offset:32768
    v_mfma_f32_16x16x32_bf16 v[184:187], v[76:79], v[92:95], v[184:187]
    ds_read_b64_tr_b16 v[104:105], v14 offset:24576
    v_mfma_f32_16x16x32_bf16 v[188:191], v[80:83], v[92:95], v[188:191]
    ds_read_b64_tr_b16 v[106:107], v14 offset:25344
    v_mfma_f32_16x16x32_bf16 v[236:239], v[84:87], v[92:95], v[236:239]
    ds_read_b64_tr_b16 v[108:109], v15 offset:24576
    v_mfma_f32_16x16x32_bf16 v[192:195], v[64:67], v[96:99], v[192:195]
    ds_read_b64_tr_b16 v[110:111], v15 offset:25344
    v_mfma_f32_16x16x32_bf16 v[196:199], v[68:71], v[96:99], v[196:199]
    buffer_load_dwordx4 a[16:19], v21, s[20:23], s39 offen sc1
    ds_read_b64_tr_b16 v[112:113], v16 offset:24576
    v_mfma_f32_16x16x32_bf16 v[240:243], v[72:75], v[96:99], v[240:243]
    ds_read_b64_tr_b16 v[114:115], v16 offset:25344
    v_mfma_f32_16x16x32_bf16 v[200:203], v[76:79], v[96:99], v[200:203]
    ds_read_b64_tr_b16 v[116:117], v14 offset:30720
    s_add_u32 s39, s39, 5120
    s_sub_u32 s49, s39, 61440
    s_cmp_eq_u32 s39, s40
    s_cselect_b32 s39, s49, s39
    v_mfma_f32_16x16x32_bf16 v[204:207], v[80:83], v[96:99], v[204:207]
    buffer_load_dwordx4 a[20:23], v20, s[20:23], s39 offen sc1
    ds_read_b64_tr_b16 v[118:119], v14 offset:31488
    v_mfma_f32_16x16x32_bf16 v[248:251], v[84:87], v[96:99], v[248:251]
    ds_read_b64_tr_b16 v[120:121], v15 offset:30720
    v_mfma_f32_16x16x32_bf16 v[208:211], v[64:67], v[100:103], v[208:211]
    ds_read_b64_tr_b16 v[122:123], v15 offset:31488
    v_mfma_f32_16x16x32_bf16 v[212:215], v[68:71], v[100:103], v[212:215]
    buffer_load_dwordx4 a[24:27], v20, s[20:23], s39 offen offset:1024 sc1
    ds_read_b64_tr_b16 v[124:125], v16 offset:30720
    v_mfma_f32_16x16x32_bf16 v[244:247], v[72:75], v[100:103], v[244:247]
    ds_read_b64_tr_b16 v[126:127], v16 offset:31488
    v_mfma_f32_16x16x32_bf16 v[216:219], v[76:79], v[100:103], v[216:219]
    ds_read_b128 v[132:135], v11 offset:34816
    v_mfma_f32_16x16x32_bf16 v[220:223], v[80:83], v[100:103], v[220:223]
    ds_read_b128 v[136:139], v11 offset:36864
    v_mfma_f32_16x16x32_bf16 v[252:255], v[84:87], v[100:103], v[252:255]
    ds_read_b128 v[140:143], v11 offset:38912
    s_waitcnt lgkmcnt(13)
    v_mfma_f32_16x16x32_bf16 v[160:163], v[104:107], v[128:131], v[160:163]
    s_waitcnt lgkmcnt(11)
    v_mfma_f32_16x16x32_bf16 v[164:167], v[108:111], v[128:131], v[164:167]
    buffer_load_dwordx4 a[28:31], v20, s[20:23], s39 offen offset:2048 sc1
    s_waitcnt lgkmcnt(9)
    v_mfma_f32_16x16x32_bf16 v[224:227], v[112:115], v[128:131], v[224:227]
    s_waitcnt lgkmcnt(7)
    v_mfma_f32_16x16x32_bf16 v[168:171], v[116:119], v[128:131], v[168:171]
    buffer_load_dwordx4 a[32:35], v20, s[20:23], s39 offen offset:3072 sc1
    s_waitcnt lgkmcnt(5)
    v_mfma_f32_16x16x32_bf16 v[172:175], v[120:123], v[128:131], v[172:175]
    s_waitcnt lgkmcnt(3)
    v_mfma_f32_16x16x32_bf16 v[232:235], v[124:127], v[128:131], v[232:235]
    buffer_load_dwordx4 a[36:39], v21, s[20:23], s39 offen sc1
    s_waitcnt lgkmcnt(2)
    v_mfma_f32_16x16x32_bf16 v[176:179], v[104:107], v[132:135], v[176:179]
    s_waitcnt lgkmcnt(0)
    v_mfma_f32_16x16x32_bf16 v[180:183], v[108:111], v[132:135], v[180:183]
    s_waitcnt vmcnt(13)
    s_barrier
    v_mfma_f32_16x16x32_bf16 v[228:231], v[112:115], v[132:135], v[228:231]
    ds_read_b128 v[88:91], v10 offset:0
    v_mfma_f32_16x16x32_bf16 v[184:187], v[116:119], v[132:135], v[184:187]
    ds_read_b64_tr_b16 v[64:65], v14 offset:36864
    v_mfma_f32_16x16x32_bf16 v[188:191], v[120:123], v[132:135], v[188:191]
    ds_read_b64_tr_b16 v[66:67], v14 offset:37632
    v_mfma_f32_16x16x32_bf16 v[236:239], v[124:127], v[132:135], v[236:239]
    ds_read_b64_tr_b16 v[68:69], v15 offset:36864
    v_mfma_f32_16x16x32_bf16 v[192:195], v[104:107], v[136:139], v[192:195]
    ds_read_b64_tr_b16 v[70:71], v15 offset:37632
    s_add_u32 s39, s39, 5120
    s_sub_u32 s49, s39, 61440
    s_cmp_eq_u32 s39, s40
    s_cselect_b32 s39, s49, s39
    v_mfma_f32_16x16x32_bf16 v[196:199], v[108:111], v[136:139], v[196:199]
    buffer_load_dwordx4 a[40:43], v20, s[20:23], s39 offen sc1
    ds_read_b64_tr_b16 v[72:73], v16 offset:36864
    v_mfma_f32_16x16x32_bf16 v[240:243], v[112:115], v[136:139], v[240:243]
    ds_read_b64_tr_b16 v[74:75], v16 offset:37632
    v_mfma_f32_16x16x32_bf16 v[200:203], v[116:119], v[136:139], v[200:203]
    ds_read_b64_tr_b16 v[76:77], v14 offset:43008
    v_mfma_f32_16x16x32_bf16 v[204:207], v[120:123], v[136:139], v[204:207]
    buffer_load_dwordx4 a[44:47], v20, s[20:23], s39 offen offset:1024 sc1
    ds_read_b64_tr_b16 v[78:79], v14 offset:43776
    v_mfma_f32_16x16x32_bf16 v[248:251], v[124:127], v[136:139], v[248:251]
    ds_read_b64_tr_b16 v[80:81], v15 offset:43008
    v_mfma_f32_16x16x32_bf16 v[208:211], v[104:107], v[140:143], v[208:211]
    ds_read_b64_tr_b16 v[82:83], v15 offset:43776
    v_mfma_f32_16x16x32_bf16 v[212:215], v[108:111], v[140:143], v[212:215]
    buffer_load_dwordx4 a[48:51], v20, s[20:23], s39 offen offset:2048 sc1
    ds_read_b64_tr_b16 v[84:85], v16 offset:43008
    v_mfma_f32_16x16x32_bf16 v[244:247], v[112:115], v[140:143], v[244:247]
    ds_read_b64_tr_b16 v[86:87], v16 offset:43776
    v_mfma_f32_16x16x32_bf16 v[216:219], v[116:119], v[140:143], v[216:219]
    ds_read_b128 v[92:95], v10 offset:2048
    v_mfma_f32_16x16x32_bf16 v[220:223], v[120:123], v[140:143], v[220:223]
    ds_read_b128 v[96:99], v10 offset:4096
    v_mfma_f32_16x16x32_bf16 v[252:255], v[124:127], v[140:143], v[252:255]
    ds_read_b128 v[100:103], v10 offset:6144
    s_waitcnt lgkmcnt(13)
    v_mfma_f32_16x16x32_bf16 v[160:163], v[64:67], v[88:91], v[160:163]
    s_waitcnt lgkmcnt(11)
    v_mfma_f32_16x16x32_bf16 v[164:167], v[68:71], v[88:91], v[164:167]
    buffer_load_dwordx4 a[52:55], v20, s[20:23], s39 offen offset:3072 sc1
    s_waitcnt lgkmcnt(9)
    v_mfma_f32_16x16x32_bf16 v[224:227], v[72:75], v[88:91], v[224:227]
    s_waitcnt lgkmcnt(7)
    v_mfma_f32_16x16x32_bf16 v[168:171], v[76:79], v[88:91], v[168:171]
    buffer_load_dwordx4 a[56:59], v21, s[20:23], s39 offen sc1
    s_waitcnt lgkmcnt(5)
    v_mfma_f32_16x16x32_bf16 v[172:175], v[80:83], v[88:91], v[172:175]
    s_add_u32 s39, s39, 5120
    s_sub_u32 s49, s39, 61440
    s_cmp_eq_u32 s39, s40
    s_cselect_b32 s39, s49, s39
    s_waitcnt lgkmcnt(3)
    v_mfma_f32_16x16x32_bf16 v[232:235], v[84:87], v[88:91], v[232:235]
    buffer_load_dwordx4 a[60:63], v20, s[20:23], s39 offen sc1
    s_waitcnt lgkmcnt(2)
    v_mfma_f32_16x16x32_bf16 v[176:179], v[64:67], v[92:95], v[176:179]
    s_waitcnt lgkmcnt(0)
    v_mfma_f32_16x16x32_bf16 v[180:183], v[68:71], v[92:95], v[180:183]
    s_waitcnt vmcnt(16)
    s_barrier
    v_mfma_f32_16x16x32_bf16 v[228:231], v[72:75], v[92:95], v[228:231]
    ds_read_b128 v[128:131], v11 offset:0
    v_mfma_f32_16x16x32_bf16 v[184:187], v[76:79], v[92:95], v[184:187]
    ds_read_b64_tr_b16 v[104:105], v14 offset:49152
    v_mfma_f32_16x16x32_bf16 v[188:191], v[80:83], v[92:95], v[188:191]
    ds_read_b64_tr_b16 v[106:107], v14 offset:49920
    v_mfma_f32_16x16x32_bf16 v[236:239], v[84:87], v[92:95], v[236:239]
    ds_read_b64_tr_b16 v[108:109], v15 offset:49152
    v_mfma_f32_16x16x32_bf16 v[192:195], v[64:67], v[96:99], v[192:195]
    ds_read_b64_tr_b16 v[110:111], v15 offset:49920
    v_mfma_f32_16x16x32_bf16 v[196:199], v[68:71], v[96:99], v[196:199]
    buffer_load_dwordx4 a[64:67], v20, s[20:23], s39 offen offset:1024 sc1
    ds_read_b64_tr_b16 v[112:113], v16 offset:49152
    v_mfma_f32_16x16x32_bf16 v[240:243], v[72:75], v[96:99], v[240:243]
    ds_read_b64_tr_b16 v[114:115], v16 offset:49920
    v_mfma_f32_16x16x32_bf16 v[200:203], v[76:79], v[96:99], v[200:203]
    ds_read_b64_tr_b16 v[116:117], v14 offset:55296
    v_mfma_f32_16x16x32_bf16 v[204:207], v[80:83], v[96:99], v[204:207]
    buffer_load_dwordx4 a[68:71], v20, s[20:23], s39 offen offset:2048 sc1
    ds_read_b64_tr_b16 v[118:119], v14 offset:56064
    v_mfma_f32_16x16x32_bf16 v[248:251], v[84:87], v[96:99], v[248:251]
    ds_read_b64_tr_b16 v[120:121], v15 offset:55296
    v_mfma_f32_16x16x32_bf16 v[208:211], v[64:67], v[100:103], v[208:211]
    ds_read_b64_tr_b16 v[122:123], v15 offset:56064
    v_mfma_f32_16x16x32_bf16 v[212:215], v[68:71], v[100:103], v[212:215]
    buffer_load_dwordx4 a[72:75], v20, s[20:23], s39 offen offset:3072 sc1
    ds_read_b64_tr_b16 v[124:125], v16 offset:55296
    v_mfma_f32_16x16x32_bf16 v[244:247], v[72:75], v[100:103], v[244:247]
    ds_read_b64_tr_b16 v[126:127], v16 offset:56064
    v_mfma_f32_16x16x32_bf16 v[216:219], v[76:79], v[100:103], v[216:219]
    ds_read_b128 v[132:135], v11 offset:2048
    v_mfma_f32_16x16x32_bf16 v[220:223], v[80:83], v[100:103], v[220:223]
    ds_read_b128 v[136:139], v11 offset:4096
    v_mfma_f32_16x16x32_bf16 v[252:255], v[84:87], v[100:103], v[252:255]
    ds_read_b128 v[140:143], v11 offset:6144
    s_waitcnt lgkmcnt(13)
    v_mfma_f32_16x16x32_bf16 v[160:163], v[104:107], v[128:131], v[160:163]
    s_waitcnt lgkmcnt(11)
    v_mfma_f32_16x16x32_bf16 v[164:167], v[108:111], v[128:131], v[164:167]
    buffer_load_dwordx4 a[76:79], v21, s[20:23], s39 offen sc1
    s_waitcnt lgkmcnt(9)
    v_mfma_f32_16x16x32_bf16 v[224:227], v[112:115], v[128:131], v[224:227]
    s_add_u32 s39, s39, 5120
    s_sub_u32 s49, s39, 61440
    s_cmp_eq_u32 s39, s40
    s_cselect_b32 s39, s49, s39
    s_waitcnt lgkmcnt(7)
    v_mfma_f32_16x16x32_bf16 v[168:171], v[116:119], v[128:131], v[168:171]
    buffer_load_dwordx4 a[80:83], v20, s[20:23], s39 offen sc1
    s_waitcnt lgkmcnt(5)
    v_mfma_f32_16x16x32_bf16 v[172:175], v[120:123], v[128:131], v[172:175]
    s_waitcnt lgkmcnt(3)
    v_mfma_f32_16x16x32_bf16 v[232:235], v[124:127], v[128:131], v[232:235]
    buffer_load_dwordx4 a[84:87], v20, s[20:23], s39 offen offset:1024 sc1
    s_waitcnt lgkmcnt(2)
    v_mfma_f32_16x16x32_bf16 v[176:179], v[104:107], v[132:135], v[176:179]
    s_waitcnt lgkmcnt(0)
    v_mfma_f32_16x16x32_bf16 v[180:183], v[108:111], v[132:135], v[180:183]
    s_barrier
    v_mfma_f32_16x16x32_bf16 v[228:231], v[112:115], v[132:135], v[228:231]
    v_mfma_f32_16x16x32_bf16 v[184:187], v[116:119], v[132:135], v[184:187]
    v_mfma_f32_16x16x32_bf16 v[188:191], v[120:123], v[132:135], v[188:191]
    v_mfma_f32_16x16x32_bf16 v[236:239], v[124:127], v[132:135], v[236:239]
    v_mfma_f32_16x16x32_bf16 v[192:195], v[104:107], v[136:139], v[192:195]
    v_mfma_f32_16x16x32_bf16 v[196:199], v[108:111], v[136:139], v[196:199]
    buffer_load_dwordx4 a[88:91], v20, s[20:23], s39 offen offset:2048 sc1
    v_mfma_f32_16x16x32_bf16 v[240:243], v[112:115], v[136:139], v[240:243]
    v_mfma_f32_16x16x32_bf16 v[200:203], v[116:119], v[136:139], v[200:203]
    v_mfma_f32_16x16x32_bf16 v[204:207], v[120:123], v[136:139], v[204:207]
    buffer_load_dwordx4 a[92:95], v20, s[20:23], s39 offen offset:3072 sc1
    v_mfma_f32_16x16x32_bf16 v[248:251], v[124:127], v[136:139], v[248:251]
    v_mfma_f32_16x16x32_bf16 v[208:211], v[104:107], v[140:143], v[208:211]
    v_mfma_f32_16x16x32_bf16 v[212:215], v[108:111], v[140:143], v[212:215]
    buffer_load_dwordx4 a[96:99], v21, s[20:23], s39 offen sc1
    v_mfma_f32_16x16x32_bf16 v[244:247], v[112:115], v[140:143], v[244:247]
    v_mfma_f32_16x16x32_bf16 v[216:219], v[116:119], v[140:143], v[216:219]
    v_mfma_f32_16x16x32_bf16 v[220:223], v[120:123], v[140:143], v[220:223]
    v_mfma_f32_16x16x32_bf16 v[252:255], v[124:127], v[140:143], v[252:255]
    s_add_u32 s39, s39, 5120
    s_sub_u32 s49, s39, 61440
    s_cmp_eq_u32 s39, s40
    s_cselect_b32 s39, s49, s39
    buffer_load_dwordx4 a[100:103], v20, s[20:23], s39 offen sc1
    s_branch L_join
L_end:
    s_endpgm
.section .rodata,"a"
.p2align 6
.amdhsa_kernel standalone__glu_gated_swiglu__prompt_kernel
  .amdhsa_next_free_vgpr 512
  .amdhsa_next_free_sgpr 102
  .amdhsa_accum_offset 256
  .amdhsa_group_segment_fixed_size 0
  .amdhsa_kernarg_size 56
  .amdhsa_user_sgpr_count 2
  .amdhsa_user_sgpr_kernarg_segment_ptr 1
  .amdhsa_system_sgpr_workgroup_id_x 1
  .amdhsa_float_denorm_mode_32 3
.end_amdhsa_kernel
```
